```python
import torch

def _softmax(x, axis=-1):
    return torch.softmax(x, dim=axis)
def _gelu(x):
    return torch.nn.functional.gelu(x, approximate="tanh")
def _silu(x):
    return torch.nn.functional.silu(x)
def _sigmoid(x):
    return torch.sigmoid(x)
def _layernorm(x, axis=-1, eps=1e-5):
    m = x.mean(dim=axis, keepdim=True)
    v = x.var(dim=axis, keepdim=True, unbiased=False)
    return (x - m) / torch.sqrt(v + eps)
def _scatter_add(tgt, idx, src, axis=0):
    return tgt.clone().index_add_(axis, idx, src)
def _segment_sum(src, seg, n):
    out = torch.zeros((n,) + src.shape[1:], dtype=src.dtype)
    return out.index_add_(0, seg, src)
def _pad(x, pw):
    flat = tuple(v for pair in reversed(pw) for v in pair)
    return torch.nn.functional.pad(x, flat)

kernel_name = 'standalone__weight_only_int_quip__sampling'

def setup_inputs():

    _w = (lambda a: (lambda t: t.to(torch.bfloat16) if t.is_floating_point() else t)(torch.as_tensor(a)))
    B, S, D, F = 32, 8, 1024, 3584
    G = -1 if -1 > 0 else D
    D = (D // G) * G
    ng = D // G
    bits = 3 if 3 > 0 else 4
    qmax = 1 << bits
    qw = torch.randint(0, qmax, (D, F)).to(torch.int32)
    U, _ = (lambda *_a, **_k: torch.linalg.qr(*[torch.as_tensor(_x).float() for _x in _a], **_k))((lambda *s: torch.randn(*s, dtype=torch.bfloat16) * 0.05)(D, D))
    V, _ = (lambda *_a, **_k: torch.linalg.qr(*[torch.as_tensor(_x).float() for _x in _a], **_k))((lambda *s: torch.randn(*s, dtype=torch.bfloat16) * 0.05)(F, F))
    return {
        "x": _w((lambda *s: torch.randn(*s, dtype=torch.bfloat16) * 0.05)(B, S, D)),
        "qw": _w(qw),
        "scales": _w(torch.abs((lambda *s: torch.randn(*s, dtype=torch.bfloat16) * 0.05)(ng, F)) * 0.02 + 0.005),
        "zeros": _w(torch.full((ng, F), qmax / 2.0, dtype=float)),
        "U": _w(U.to(float)),
        "V": _w(V.to(float)),
    }

def reference(x, qw, scales, zeros, U, V):
    B, S, D = x.shape
    ng, F = scales.shape
    G = D // ng
    s = (lambda x, n, axis: torch.repeat_interleave(x, n, dim=axis))(scales, G, axis=0)
    z = (lambda x, n, axis: torch.repeat_interleave(x, n, dim=axis))(zeros, G, axis=0)
    wq = ((lambda x, dt: x.to(dt))(qw, x.dtype) - z) * s
    xr = torch.einsum("bsd,de->bse", x, U)
    h  = torch.einsum("bse,ef->bsf", xr, wq)
    y  = torch.einsum("bsf,fg->bsg", h, V)
    return y
```

```asm
; @launch grid=(256,1,1) block=(256,1,1) lds=163840
.amdgcn_target "amdgcn-amd-amdhsa--gfx950"
.text
.globl standalone__weight_only_int_quip__sampling_kernel
.p2align 8
.type standalone__weight_only_int_quip__sampling_kernel,@function
standalone__weight_only_int_quip__sampling_kernel:
    s_cmp_ge_u32 s2, 256
    s_cbranch_scc1 kend
    s_load_dwordx16 s[8:23], s[0:1], 0
    s_load_dwordx2 s[24:25], s[0:1], 64
    s_memrealtime s[72:73]
    s_getpc_b64 s[64:65]
pcbase:
    s_mov_b32 s66, kend-pcbase
    s_mov_b32 s67, 0x20000
    s_lshr_b32 s85, s2, 3
    s_mul_i32 s82, s85, ((kend-pcbase+4095)/4096)*128
    v_lshlrev_b32 v254, 7, v0
    v_cmp_gt_u32 vcc, (kend-pcbase+4095)/4096, v0
    s_and_saveexec_b64 s[6:7], vcc
    s_cbranch_execz pfskip
    buffer_load_dword v255, v254, s[64:67], s82 offen
pfskip:
    s_mov_b64 exec, -1
    v_lshrrev_b32 v1, 6, v0
    v_and_b32 v0, 63, v0
    v_readfirstlane_b32 s68, v1
    s_and_b32 s84, s2, 7
    s_and_b32 s69, s85, 3
    s_mul_i32 s81, s68, 40960
    v_lshlrev_b32 v1, 4, v0
    s_cmp_ge_u32 s85, 28
    s_cbranch_scc1 cls_S
cls_C:
    s_lshl2_add_u32 s82, s85, s68
    v_lshrrev_b32 v128, 2, v0
    v_lshlrev_b32 v128, 11, v128
    v_and_b32 v129, 3, v0
    v_lshl_add_u32 v128, v129, 7, v128
    v_lshlrev_b32 v129, 7, v0
    s_lshl_b32 s26, s82, 13
    s_and_b32 s83, s84, 1
    s_lshl_b32 s83, s83, 18
    s_add_u32 s26, s26, s83
    s_sub_u32 s83, s82, 32
    s_lshl_b32 s27, s83, 15
    s_lshr_b32 s83, s84, 1
    s_lshl_b32 s83, s83, 9
    s_add_u32 s27, s27, s83
    s_lshr_b32 s70, s85, 2
    s_mul_i32 s71, s84, 7
    s_add_u32 s71, s71, s70
    s_add_u32 s70, s69, s70
    s_and_b32 s64, s70, 3
    s_and_b32 s83, s70, 2
    s_add_u32 s64, s64, s83
    s_lshl_b32 s64, s64, 10
    v_and_b32 v130, 15, v0
    s_and_b32 s83, s68, 2
    v_xor_b32 v130, s83, v130
    v_lshrrev_b32 v131, 4, v0
    v_mul_u32_u24 v12, 57344, v131
    v_lshl_add_u32 v12, v130, 4, v12
    s_mul_i32 s3, s68, 3670016
    s_lshl_b32 s83, s71, 8
    s_add_u32 s3, s3, s83
    v_add_u32 v12, s3, v12
    v_lshlrev_b32 v130, 3, v130
    s_waitcnt lgkmcnt(0)
    s_cmp_ge_u32 s82, 32
    s_cbranch_scc1 tchU
    s_mov_b64 s[28:29], s[8:9]
    s_mov_b32 s30, 524288
    s_mov_b32 s31, 0x20000
    buffer_load_dword v15, v129, s[28:31], s26 offen
    s_branch tchE
tchU:
    s_cmp_ge_u32 s82, 96
    s_cbranch_scc1 tchT
    s_mov_b64 s[44:45], s[16:17]
    s_mov_b32 s46, 2097152
    s_mov_b32 s47, 0x20000
    buffer_load_dword v15, v128, s[44:47], s27 offen
    s_branch tchE
tchT:
    s_lshl2_add_u32 s83, s2, s68
    s_cmp_lg_u32 s83, 768
    s_cbranch_scc1 tchE
    s_mov_b64 s[60:61], s[22:23]
    s_mov_b32 s62, 256
    s_mov_b32 s63, 0x20000
    v_mov_b32 v2, s72
    v_mov_b32 v3, s73
    s_mov_b64 exec, 1
    buffer_store_dwordx2 v[2:3], off, s[60:63], 0 sc1
    s_mov_b64 exec, -1
tchE:
    s_mov_b64 s[36:37], s[12:13]
    s_mov_b32 s38, 7168
    s_mov_b32 s39, 0x20000
    s_mov_b64 s[40:41], s[14:15]
    s_mov_b32 s42, 7168
    s_mov_b32 s43, 0x20000
    s_mov_b64 s[32:33], s[10:11]
    s_mov_b32 s34, 14680064
    s_mov_b32 s35, 0x20000
    s_lshl_b32 s82, s71, 7
    buffer_load_dwordx2 v[224:225], v130, s[36:39], s82 offen
    buffer_load_dwordx2 v[228:229], v130, s[40:43], s82 offen
    s_mul_i32 s26, s64, 448
    buffer_load_dwordx4 v[32:35], v12, s[32:35], s26 offen nt
    s_add_u32 s26, s26, 14336
    buffer_load_dwordx4 v[36:39], v12, s[32:35], s26 offen nt
    s_add_u32 s26, s26, 14336
    buffer_load_dwordx4 v[40:43], v12, s[32:35], s26 offen nt
    s_add_u32 s26, s26, 14336
    buffer_load_dwordx4 v[44:47], v12, s[32:35], s26 offen nt
    s_add_u32 s26, s26, 186368
    buffer_load_dwordx4 v[48:51], v12, s[32:35], s26 offen nt
    s_add_u32 s26, s26, 14336
    buffer_load_dwordx4 v[52:55], v12, s[32:35], s26 offen nt
    s_mov_b64 s[60:61], s[22:23]
    s_mov_b32 s62, 256
    s_mov_b32 s63, 0x20000
    s_mov_b64 s[56:57], s[24:25]
    s_mov_b32 s58, 33554432
    s_mov_b32 s59, 0x20000
    s_mov_b64 s[48:49], s[18:19]
    s_mov_b32 s50, 25690112
    s_mov_b32 s51, 0x20000
    s_mov_b64 s[52:53], s[20:21]
    s_mov_b32 s54, 1835008
    s_mov_b32 s55, 0x20000
    s_setreg_imm32_b32 hwreg(HW_REG_MODE, 4, 2), 3
    s_add_u32 s70, s70, 1
    s_and_b32 s65, s70, 3
    s_and_b32 s83, s70, 2
    s_add_u32 s65, s65, s83
    s_lshl_b32 s65, s65, 10
    s_add_u32 s70, s70, 1
    s_and_b32 s66, s70, 3
    s_and_b32 s83, s70, 2
    s_add_u32 s66, s66, s83
    s_lshl_b32 s66, s66, 10
    s_add_u32 s70, s70, 1
    s_and_b32 s67, s70, 3
    s_and_b32 s83, s70, 2
    s_add_u32 s67, s67, s83
    s_lshl_b32 s67, s67, 10
    s_lshr_b32 s82, s68, 1
    s_lshl1_add_u32 s82, s71, s82
    s_and_b32 s83, s68, 1
    s_lshl2_add_u32 s82, s82, s83
    s_lshl_b32 s82, s82, 13
    s_add_u32 s0, s82, 20971520
    s_lshr_b32 s3, s84, 1
    s_and_b32 s82, s84, 1
    s_mul_i32 s82, s82, 28
    s_add_u32 s4, s82, s85
    s_xor_b32 s5, s85, s68
    s_and_b32 s5, s5, 1
    s_lshl_b32 s5, s5, 7
    s_lshl2_add_u32 s82, s3, s68
    s_mul_i32 s82, s82, 7
    s_lshr_b32 s83, s85, 2
    s_add_u32 s74, s82, s83
    s_lshl_b32 s74, s74, 10
    s_add_u32 s83, s83, 1
    s_cmp_ge_u32 s83, 7
    s_cselect_b32 s83, 0, s83
    s_add_u32 s75, s82, s83
    s_lshl_b32 s75, s75, 10
    s_add_u32 s83, s83, 1
    s_cmp_ge_u32 s83, 7
    s_cselect_b32 s83, 0, s83
    s_add_u32 s76, s82, s83
    s_lshl_b32 s76, s76, 10
    s_add_u32 s83, s83, 1
    s_cmp_ge_u32 s83, 7
    s_cselect_b32 s83, 0, s83
    s_add_u32 s77, s82, s83
    s_lshl_b32 s77, s77, 10
    s_add_u32 s83, s83, 1
    s_cmp_ge_u32 s83, 7
    s_cselect_b32 s83, 0, s83
    s_add_u32 s78, s82, s83
    s_lshl_b32 s78, s78, 10
    s_add_u32 s83, s83, 1
    s_cmp_ge_u32 s83, 7
    s_cselect_b32 s83, 0, s83
    s_add_u32 s79, s82, s83
    s_lshl_b32 s79, s79, 10
    s_add_u32 s83, s83, 1
    s_cmp_ge_u32 s83, 7
    s_cselect_b32 s83, 0, s83
    s_add_u32 s80, s82, s83
    s_lshl_b32 s80, s80, 10
    s_lshr_b32 s83, s3, 1
    s_xor_b32 s83, s83, s3
    s_xor_b32 s83, s83, s69
    s_lshl_b32 s83, s83, 1
    s_xor_b32 s83, s83, s68
    s_and_b32 s83, s83, 2
    s_xor_b32 s83, s83, s68
    s_xor_b32 s82, s83, 0
    s_lshl2_add_u32 s82, s69, s82
    s_lshl2_add_u32 s82, s82, s68
    s_lshl_b32 s28, s82, 13
    s_xor_b32 s82, s83, 1
    s_lshl2_add_u32 s82, s69, s82
    s_lshl2_add_u32 s82, s82, s68
    s_lshl_b32 s29, s82, 13
    s_xor_b32 s82, s83, 2
    s_lshl2_add_u32 s82, s69, s82
    s_lshl2_add_u32 s82, s82, s68
    s_lshl_b32 s30, s82, 13
    s_xor_b32 s82, s83, 3
    s_lshl2_add_u32 s82, s69, s82
    s_lshl2_add_u32 s82, s82, s68
    s_lshl_b32 s31, s82, 13
    v_lshrrev_b32 v128, 3, v0
    v_and_b32 v129, 6, v128
    v_and_b32 v130, 7, v0
    v_xor_b32 v129, v129, v130
    v_lshlrev_b32 v129, 4, v129
    v_and_b32 v128, 3, v128
    v_lshrrev_b32 v130, 5, v0
    v_lshl_add_u32 v128, v130, 4, v128
    v_mul_u32_u24 v128, 7168, v128
    v_add_u32 v128, v128, v129
    s_lshr_b32 s82, s4, 1
    s_lshl_b32 s82, s82, 8
    v_add_u32 v4, s82, v128
    v_add_u32 v5, 228352, v4
    v_add_u32 v6, 26624, v4
    v_add_u32 v7, 254976, v4
    v_lshrrev_b32 v128, 2, v0
    v_and_b32 v129, 6, v128
    v_and_b32 v130, 3, v0
    v_xor_b32 v129, v129, v130
    v_lshlrev_b32 v129, 4, v129
    v_lshl_add_u32 v8, v128, 7, v129
    v_xor_b32 v9, 8, v8
    v_xor_b32 v10, 64, v8
    v_xor_b32 v11, 72, v8
    v_add_u32 v8, s81, v8
    v_add_u32 v9, s81, v9
    v_add_u32 v10, s81, v10
    v_add_u32 v11, s81, v11
    v_lshlrev_b32 v0, 3, v0
    v_accvgpr_write_b32 a220, -1
    v_accvgpr_write_b32 a221, -1
    v_accvgpr_write_b32 a222, -1
    v_accvgpr_write_b32 a223, -1
    s_waitcnt vmcnt(7)
    s_add_u32 s26, s26, 14336
    buffer_load_dwordx4 v[56:59], v12, s[32:35], s26 offen nt
    s_waitcnt vmcnt(7)
    s_add_u32 s26, s26, 14336
    buffer_load_dwordx4 v[60:63], v12, s[32:35], s26 offen nt
    v_and_b32 v227, 0xffff0000, v225
    v_lshlrev_b32 v226, 16, v225
    v_and_b32 v225, 0xffff0000, v224
    v_lshlrev_b32 v224, 16, v224
    v_and_b32 v231, 0xffff0000, v229
    v_lshlrev_b32 v230, 16, v229
    v_and_b32 v229, 0xffff0000, v228
    v_lshlrev_b32 v228, 16, v228
    v_sub_f32 v232, 0, v228
    v_sub_f32 v233, 0, v229
    v_sub_f32 v234, 0, v230
    v_sub_f32 v235, 0, v231
    v_sub_f32 v236, 1.0, v228
    v_sub_f32 v237, 1.0, v229
    v_sub_f32 v238, 1.0, v230
    v_sub_f32 v239, 1.0, v231
    v_cvt_pk_bf16_f32 v232, v232, v236
    v_cvt_pk_bf16_f32 v233, v233, v237
    v_cvt_pk_bf16_f32 v234, v234, v238
    v_cvt_pk_bf16_f32 v235, v235, v239
    v_and_b32 v236, 0xffff0000, v232
    v_and_b32 v237, 0xffff0000, v233
    v_and_b32 v238, 0xffff0000, v234
    v_and_b32 v239, 0xffff0000, v235
    v_lshlrev_b32 v232, 16, v232
    v_lshlrev_b32 v233, 16, v233
    v_lshlrev_b32 v234, 16, v234
    v_lshlrev_b32 v235, 16, v235
    v_mul_f32 v236, v236, v224
    v_mul_f32 v237, v237, v225
    v_mul_f32 v238, v238, v226
    v_mul_f32 v239, v239, v227
    v_mul_f32 v232, v232, v224
    v_mul_f32 v233, v233, v225
    v_mul_f32 v234, v234, v226
    v_mul_f32 v235, v235, v227
    v_cvt_pk_bf16_f32 v192, v232, v236
    v_cvt_pk_bf16_f32 v193, v233, v237
    v_cvt_pk_bf16_f32 v194, v234, v238
    v_cvt_pk_bf16_f32 v195, v235, v239
    s_lshl2_add_u32 s82, s69, s68
    s_mul_i32 s82, s82, 56
    s_add_u32 s82, s82, s71
    s_lshl_b32 s82, s82, 11
    s_add_u32 s82, s82, 1048576
    buffer_store_dwordx4 a[220:223], v1, s[56:59], s82 offen offset:0 sc1
    buffer_store_dwordx4 a[220:223], v1, s[56:59], s82 offen offset:1024 sc1
    v_sub_f32 v232, 2.0, v228
    v_sub_f32 v233, 2.0, v229
    v_sub_f32 v234, 2.0, v230
    v_sub_f32 v235, 2.0, v231
    v_sub_f32 v236, 0x40400000, v228
    v_sub_f32 v237, 0x40400000, v229
    v_sub_f32 v238, 0x40400000, v230
    v_sub_f32 v239, 0x40400000, v231
    v_cvt_pk_bf16_f32 v232, v232, v236
    v_cvt_pk_bf16_f32 v233, v233, v237
    v_cvt_pk_bf16_f32 v234, v234, v238
    v_cvt_pk_bf16_f32 v235, v235, v239
    v_and_b32 v236, 0xffff0000, v232
    v_and_b32 v237, 0xffff0000, v233
    v_and_b32 v238, 0xffff0000, v234
    v_and_b32 v239, 0xffff0000, v235
    v_lshlrev_b32 v232, 16, v232
    v_lshlrev_b32 v233, 16, v233
    v_lshlrev_b32 v234, 16, v234
    v_lshlrev_b32 v235, 16, v235
    v_mul_f32 v236, v236, v224
    v_mul_f32 v237, v237, v225
    v_mul_f32 v238, v238, v226
    v_mul_f32 v239, v239, v227
    v_mul_f32 v232, v232, v224
    v_mul_f32 v233, v233, v225
    v_mul_f32 v234, v234, v226
    v_mul_f32 v235, v235, v227
    v_cvt_pk_bf16_f32 v196, v232, v236
    v_cvt_pk_bf16_f32 v197, v233, v237
    v_cvt_pk_bf16_f32 v198, v234, v238
    v_cvt_pk_bf16_f32 v199, v235, v239
    v_sub_f32 v232, 4.0, v228
    v_sub_f32 v233, 4.0, v229
    v_sub_f32 v234, 4.0, v230
    v_sub_f32 v235, 4.0, v231
    v_sub_f32 v236, 0x40a00000, v228
    v_sub_f32 v237, 0x40a00000, v229
    v_sub_f32 v238, 0x40a00000, v230
    v_sub_f32 v239, 0x40a00000, v231
    v_cvt_pk_bf16_f32 v232, v232, v236
    v_cvt_pk_bf16_f32 v233, v233, v237
    v_cvt_pk_bf16_f32 v234, v234, v238
    v_cvt_pk_bf16_f32 v235, v235, v239
    v_and_b32 v236, 0xffff0000, v232
    v_and_b32 v237, 0xffff0000, v233
    v_and_b32 v238, 0xffff0000, v234
    v_and_b32 v239, 0xffff0000, v235
    v_lshlrev_b32 v232, 16, v232
    v_lshlrev_b32 v233, 16, v233
    v_lshlrev_b32 v234, 16, v234
    v_lshlrev_b32 v235, 16, v235
    v_mul_f32 v236, v236, v224
    v_mul_f32 v237, v237, v225
    v_mul_f32 v238, v238, v226
    v_mul_f32 v239, v239, v227
    v_mul_f32 v232, v232, v224
    v_mul_f32 v233, v233, v225
    v_mul_f32 v234, v234, v226
    v_mul_f32 v235, v235, v227
    v_cvt_pk_bf16_f32 v200, v232, v236
    v_cvt_pk_bf16_f32 v201, v233, v237
    v_cvt_pk_bf16_f32 v202, v234, v238
    v_cvt_pk_bf16_f32 v203, v235, v239
    v_sub_f32 v232, 0x40c00000, v228
    v_sub_f32 v233, 0x40c00000, v229
    v_sub_f32 v234, 0x40c00000, v230
    v_sub_f32 v235, 0x40c00000, v231
    v_sub_f32 v236, 0x40e00000, v228
    v_sub_f32 v237, 0x40e00000, v229
    v_sub_f32 v238, 0x40e00000, v230
    v_sub_f32 v239, 0x40e00000, v231
    v_cvt_pk_bf16_f32 v232, v232, v236
    v_cvt_pk_bf16_f32 v233, v233, v237
    v_cvt_pk_bf16_f32 v234, v234, v238
    v_cvt_pk_bf16_f32 v235, v235, v239
    v_and_b32 v236, 0xffff0000, v232
    v_and_b32 v237, 0xffff0000, v233
    v_and_b32 v238, 0xffff0000, v234
    v_and_b32 v239, 0xffff0000, v235
    v_lshlrev_b32 v232, 16, v232
    v_lshlrev_b32 v233, 16, v233
    v_lshlrev_b32 v234, 16, v234
    v_lshlrev_b32 v235, 16, v235
    v_mul_f32 v236, v236, v224
    v_mul_f32 v237, v237, v225
    v_mul_f32 v238, v238, v226
    v_mul_f32 v239, v239, v227
    v_mul_f32 v232, v232, v224
    v_mul_f32 v233, v233, v225
    v_mul_f32 v234, v234, v226
    v_mul_f32 v235, v235, v227
    v_cvt_pk_bf16_f32 v204, v232, v236
    v_cvt_pk_bf16_f32 v205, v233, v237
    v_cvt_pk_bf16_f32 v206, v234, v238
    v_cvt_pk_bf16_f32 v207, v235, v239
    s_mov_b32 s6, 0x06040200
    s_mov_b32 s7, 0x07050301
    v_perm_b32 v16, v196, v192, s6
    v_perm_b32 v18, v196, v192, s7
    v_perm_b32 v17, v204, v200, s6
    v_perm_b32 v19, v204, v200, s7
    v_perm_b32 v20, v197, v193, s6
    v_perm_b32 v22, v197, v193, s7
    v_perm_b32 v21, v205, v201, s6
    v_perm_b32 v23, v205, v201, s7
    v_perm_b32 v24, v198, v194, s6
    v_perm_b32 v26, v198, v194, s7
    v_perm_b32 v25, v206, v202, s6
    v_perm_b32 v27, v206, v202, s7
    v_perm_b32 v28, v199, v195, s6
    v_perm_b32 v30, v199, v195, s7
    v_perm_b32 v29, v207, v203, s6
    v_perm_b32 v31, v207, v203, s7
    s_mov_b32 s6, 0x05010400
    s_mov_b32 s7, 0x07030602
    s_waitcnt vmcnt(9)
    buffer_load_dwordx2 v[2:3], off, s[60:63], 0 sc1
    s_waitcnt vmcnt(9)
    s_mul_i32 s26, s64, 448
    s_add_u32 s26, s26, 917504
    buffer_load_dwordx4 v[64:67], v12, s[32:35], s26 offen nt
    s_waitcnt vmcnt(9)
    s_add_u32 s26, s26, 14336
    buffer_load_dwordx4 v[68:71], v12, s[32:35], s26 offen nt
    s_waitcnt vmcnt(9)
    s_add_u32 s26, s26, 14336
    buffer_load_dwordx4 v[72:75], v12, s[32:35], s26 offen nt
    s_waitcnt vmcnt(9)
    s_add_u32 s26, s26, 14336
    buffer_load_dwordx4 v[76:79], v12, s[32:35], s26 offen nt
    s_waitcnt vmcnt(9)
    s_add_u32 s26, s26, 186368
    buffer_load_dwordx4 v[80:83], v12, s[32:35], s26 offen nt
    s_waitcnt vmcnt(9)
    s_add_u32 s26, s26, 14336
    buffer_load_dwordx4 v[84:87], v12, s[32:35], s26 offen nt
    s_waitcnt vmcnt(9)
    s_add_u32 s26, s26, 14336
    buffer_load_dwordx4 v[88:91], v12, s[32:35], s26 offen nt
    s_waitcnt vmcnt(7)
    s_add_u32 s26, s26, 14336
    buffer_load_dwordx4 v[92:95], v12, s[32:35], s26 offen nt
    s_mov_b32 s85, 30000
tokl_1:
    v_readfirstlane_b32 s72, v2
    v_readfirstlane_b32 s73, v3
    s_cmp_lg_u64 s[72:73], 0
    s_cbranch_scc1 toko_2
    s_sub_u32 s85, s85, 1
    s_cbranch_scc1 toko_2
    buffer_load_dwordx2 v[2:3], off, s[60:63], 0 sc1
    s_waitcnt vmcnt(0)
    s_branch tokl_1
toko_2:
    s_mov_b32 s1, 0x88888888
    s_lshl_b32 s44, s72, 3
    s_and_b32 s44, s44, s1
    s_lshl_b32 s45, s72, 2
    s_and_b32 s45, s45, s1
    s_lshl_b32 s46, s72, 1
    s_and_b32 s46, s46, s1
    s_and_b32 s47, s72, s1
    v_cvt_pk_u16_u32 v128, v32, v40
    v_cvt_pk_u16_u32 v129, v36, v44
    v_cvt_pk_u16_u32 v132, v33, v41
    v_cvt_pk_u16_u32 v133, v37, v45
    v_cvt_pk_u16_u32 v136, v34, v42
    v_cvt_pk_u16_u32 v137, v38, v46
    v_cvt_pk_u16_u32 v140, v35, v43
    v_cvt_pk_u16_u32 v141, v39, v47
    v_cvt_pk_u16_u32 v130, v48, v56
    v_cvt_pk_u16_u32 v131, v52, v60
    v_cvt_pk_u16_u32 v134, v49, v57
    v_cvt_pk_u16_u32 v135, v53, v61
    v_cvt_pk_u16_u32 v138, v50, v58
    v_cvt_pk_u16_u32 v139, v54, v62
    v_cvt_pk_u16_u32 v142, v51, v59
    v_cvt_pk_u16_u32 v143, v55, v63
    v_or3_b32 v13, v128, v129, v130
    v_or3_b32 v14, v131, v132, v133
    v_or3_b32 v13, v13, v134, v135
    v_or3_b32 v14, v14, v136, v137
    v_or3_b32 v13, v13, v138, v139
    v_or3_b32 v14, v14, v140, v141
    v_or3_b32 v13, v13, v142, v143
    v_or_b32 v13, v13, v14
    v_and_b32 v13, 0xfff8fff8, v13
    v_cmp_ne_u32 vcc, 0, v13
    v_lshl_or_b32 v96, v129, 8, v128
    v_lshl_or_b32 v97, v131, 8, v130
    v_lshl_or_b32 v98, v133, 8, v132
    v_lshl_or_b32 v99, v135, 8, v134
    v_lshl_or_b32 v100, v137, 8, v136
    v_lshl_or_b32 v101, v139, 8, v138
    v_lshl_or_b32 v102, v141, 8, v140
    v_lshl_or_b32 v103, v143, 8, v142
    s_lshl2_add_u32 s82, s64, s0
    s_cbranch_vccnz dqg0
    v_lshl_or_b32 v40, v97, 4, v96
    v_lshl_or_b32 v41, v99, 4, v98
    v_lshl_or_b32 v42, v101, 4, v100
    v_lshl_or_b32 v43, v103, 4, v102
    v_or_b32 v40, s44, v40
    v_or_b32 v41, s45, v41
    v_or_b32 v42, s46, v42
    v_or_b32 v43, s47, v43
    buffer_store_dwordx4 v[40:43], v1, s[56:59], s82 offen offset:0 sc1
    v_perm_b32 v129, v17, v16, v96
    v_perm_b32 v104, v19, v18, v96
    v_perm_b32 v133, v21, v20, v98
    v_perm_b32 v105, v23, v22, v98
    v_perm_b32 v137, v25, v24, v100
    v_perm_b32 v106, v27, v26, v100
    v_perm_b32 v141, v29, v28, v102
    v_perm_b32 v107, v31, v30, v102
    v_perm_b32 v128, v104, v129, s6
    v_perm_b32 v129, v104, v129, s7
    v_perm_b32 v132, v105, v133, s6
    v_perm_b32 v133, v105, v133, s7
    v_perm_b32 v136, v106, v137, s6
    v_perm_b32 v137, v106, v137, s7
    v_perm_b32 v140, v107, v141, s6
    v_perm_b32 v141, v107, v141, s7
    v_perm_b32 v131, v17, v16, v97
    v_perm_b32 v108, v19, v18, v97
    v_perm_b32 v135, v21, v20, v99
    v_perm_b32 v109, v23, v22, v99
    v_perm_b32 v139, v25, v24, v101
    v_perm_b32 v110, v27, v26, v101
    v_perm_b32 v143, v29, v28, v103
    v_perm_b32 v111, v31, v30, v103
    v_perm_b32 v130, v108, v131, s6
    v_perm_b32 v131, v108, v131, s7
    v_perm_b32 v134, v109, v135, s6
    v_perm_b32 v135, v109, v135, s7
    v_perm_b32 v138, v110, v139, s6
    v_perm_b32 v139, v110, v139, s7
    v_perm_b32 v142, v111, v143, s6
    v_perm_b32 v143, v111, v143, s7
dqr0:
    s_waitcnt vmcnt(8)
    s_add_u32 m0, s81, 0
    s_lshr_b32 s27, s74, 11
    s_mul_i32 s27, s27, 458752
    s_bitcmp1_b32 s74, 10
    s_cselect_b32 s82, 57344, 0
    s_add_u32 s27, s27, s82
    s_add_u32 s27, s27, s5
    buffer_load_dwordx4 v4, s[48:51], s27 offen offset:0  lds
    s_waitcnt vmcnt(8)
    buffer_load_dwordx4 v5, s[48:51], s27 offen offset:1024  lds
    s_waitcnt vmcnt(8)
    buffer_load_dwordx4 v6, s[48:51], s27 offen offset:2048  lds
    s_waitcnt vmcnt(8)
    buffer_load_dwordx4 v7, s[48:51], s27 offen offset:3072  lds
    s_lshr_b32 s82, s69, 1
    s_mul_i32 s82, s82, 56
    s_add_u32 s82, s82, s71
    s_and_b32 s83, s69, 1
    s_lshl1_add_u32 s82, s82, s83
    s_lshl2_add_u32 s82, s82, s68
    s_lshl_b32 s82, s82, 3
    s_add_u32 s82, s82, 3149824
    v_mov_b32 v14, s72
    v_mov_b32 v15, s73
    s_mov_b64 exec, 1
    buffer_store_dwordx2 v[14:15], off, s[56:59], s82 sc1
    s_mov_b64 exec, -1
    s_waitcnt vmcnt(9)
    s_add_u32 m0, s81, 4096
    s_lshr_b32 s27, s75, 11
    s_mul_i32 s27, s27, 458752
    s_bitcmp1_b32 s75, 10
    s_cselect_b32 s82, 57344, 0
    s_add_u32 s27, s27, s82
    s_add_u32 s27, s27, s5
    buffer_load_dwordx4 v4, s[48:51], s27 offen offset:0  lds
    s_waitcnt vmcnt(9)
    buffer_load_dwordx4 v5, s[48:51], s27 offen offset:1024  lds
    s_waitcnt vmcnt(9)
    buffer_load_dwordx4 v6, s[48:51], s27 offen offset:2048  lds
    s_waitcnt vmcnt(9)
    buffer_load_dwordx4 v7, s[48:51], s27 offen offset:3072  lds
    v_cvt_pk_u16_u32 v144, v64, v72
    v_cvt_pk_u16_u32 v145, v68, v76
    v_cvt_pk_u16_u32 v148, v65, v73
    v_cvt_pk_u16_u32 v149, v69, v77
    v_cvt_pk_u16_u32 v152, v66, v74
    v_cvt_pk_u16_u32 v153, v70, v78
    v_cvt_pk_u16_u32 v156, v67, v75
    v_cvt_pk_u16_u32 v157, v71, v79
    v_cvt_pk_u16_u32 v146, v80, v88
    v_cvt_pk_u16_u32 v147, v84, v92
    v_cvt_pk_u16_u32 v150, v81, v89
    v_cvt_pk_u16_u32 v151, v85, v93
    v_cvt_pk_u16_u32 v154, v82, v90
    v_cvt_pk_u16_u32 v155, v86, v94
    v_cvt_pk_u16_u32 v158, v83, v91
    v_cvt_pk_u16_u32 v159, v87, v95
    v_or3_b32 v13, v144, v145, v146
    v_or3_b32 v14, v147, v148, v149
    v_or3_b32 v13, v13, v150, v151
    v_or3_b32 v14, v14, v152, v153
    v_or3_b32 v13, v13, v154, v155
    v_or3_b32 v14, v14, v156, v157
    v_or3_b32 v13, v13, v158, v159
    v_or_b32 v13, v13, v14
    v_and_b32 v13, 0xfff8fff8, v13
    v_cmp_ne_u32 vcc, 0, v13
    v_lshl_or_b32 v112, v145, 8, v144
    v_lshl_or_b32 v113, v147, 8, v146
    v_lshl_or_b32 v114, v149, 8, v148
    v_lshl_or_b32 v115, v151, 8, v150
    v_lshl_or_b32 v116, v153, 8, v152
    v_lshl_or_b32 v117, v155, 8, v154
    v_lshl_or_b32 v118, v157, 8, v156
    v_lshl_or_b32 v119, v159, 8, v158
    s_lshl2_add_u32 s82, s64, s0
    s_cbranch_vccnz dqg1
    v_lshl_or_b32 v72, v113, 4, v112
    v_lshl_or_b32 v73, v115, 4, v114
    v_lshl_or_b32 v74, v117, 4, v116
    v_lshl_or_b32 v75, v119, 4, v118
    v_or_b32 v72, s44, v72
    v_or_b32 v73, s45, v73
    v_or_b32 v74, s46, v74
    v_or_b32 v75, s47, v75
    buffer_store_dwordx4 v[72:75], v1, s[56:59], s82 offen offset:2048 sc1
    v_perm_b32 v145, v17, v16, v112
    v_perm_b32 v120, v19, v18, v112
    v_perm_b32 v149, v21, v20, v114
    v_perm_b32 v121, v23, v22, v114
    v_perm_b32 v153, v25, v24, v116
    v_perm_b32 v122, v27, v26, v116
    v_perm_b32 v157, v29, v28, v118
    v_perm_b32 v123, v31, v30, v118
    v_perm_b32 v144, v120, v145, s6
    v_perm_b32 v145, v120, v145, s7
    v_perm_b32 v148, v121, v149, s6
    v_perm_b32 v149, v121, v149, s7
    v_perm_b32 v152, v122, v153, s6
    v_perm_b32 v153, v122, v153, s7
    v_perm_b32 v156, v123, v157, s6
    v_perm_b32 v157, v123, v157, s7
    v_perm_b32 v147, v17, v16, v113
    v_perm_b32 v124, v19, v18, v113
    v_perm_b32 v151, v21, v20, v115
    v_perm_b32 v125, v23, v22, v115
    v_perm_b32 v155, v25, v24, v117
    v_perm_b32 v126, v27, v26, v117
    v_perm_b32 v159, v29, v28, v119
    v_perm_b32 v127, v31, v30, v119
    v_perm_b32 v146, v124, v147, s6
    v_perm_b32 v147, v124, v147, s7
    v_perm_b32 v150, v125, v151, s6
    v_perm_b32 v151, v125, v151, s7
    v_perm_b32 v154, v126, v155, s6
    v_perm_b32 v155, v126, v155, s7
    v_perm_b32 v158, v127, v159, s6
    v_perm_b32 v159, v127, v159, s7
dqr1:
    s_waitcnt vmcnt(9)
    s_add_u32 m0, s81, 8192
    s_lshr_b32 s27, s76, 11
    s_mul_i32 s27, s27, 458752
    s_bitcmp1_b32 s76, 10
    s_cselect_b32 s82, 57344, 0
    s_add_u32 s27, s27, s82
    s_add_u32 s27, s27, s5
    buffer_load_dwordx4 v4, s[48:51], s27 offen offset:0  lds
    s_waitcnt vmcnt(9)
    buffer_load_dwordx4 v5, s[48:51], s27 offen offset:1024  lds
    s_waitcnt vmcnt(9)
    buffer_load_dwordx4 v6, s[48:51], s27 offen offset:2048  lds
    s_waitcnt vmcnt(9)
    buffer_load_dwordx4 v7, s[48:51], s27 offen offset:3072  lds
    s_waitcnt vmcnt(8)
    s_add_u32 m0, s81, 12288
    s_lshr_b32 s27, s74, 11
    s_mul_i32 s27, s27, 458752
    s_bitcmp1_b32 s74, 10
    s_cselect_b32 s82, 57344, 0
    s_add_u32 s27, s27, s82
    s_add_u32 s27, s27, s5
    s_xor_b32 s27, s27, 128
    buffer_load_dwordx4 v4, s[48:51], s27 offen offset:0  lds
    s_waitcnt vmcnt(8)
    buffer_load_dwordx4 v5, s[48:51], s27 offen offset:1024  lds
    s_waitcnt vmcnt(8)
    buffer_load_dwordx4 v6, s[48:51], s27 offen offset:2048  lds
    s_waitcnt vmcnt(8)
    buffer_load_dwordx4 v7, s[48:51], s27 offen offset:3072  lds
    ds_read_b64_tr_b16 a[0:1], v8 offset:0
    ds_read_b64_tr_b16 a[2:3], v8 offset:2048
    ds_read_b64_tr_b16 a[4:5], v9 offset:0
    ds_read_b64_tr_b16 a[6:7], v9 offset:2048
    ds_read_b64_tr_b16 a[8:9], v10 offset:0
    ds_read_b64_tr_b16 a[10:11], v10 offset:2048
    ds_read_b64_tr_b16 a[12:13], v11 offset:0
    ds_read_b64_tr_b16 a[14:15], v11 offset:2048
    s_waitcnt vmcnt(7)
    s_lshl2_add_u32 s82, s65, s0
    buffer_load_dwordx4 v[168:171], v1, s[56:59], s82 offen offset:0 sc1
    s_waitcnt vmcnt(7)
    s_lshl2_add_u32 s82, s66, s0
    buffer_load_dwordx4 v[184:187], v1, s[56:59], s82 offen offset:0 sc1
    s_waitcnt vmcnt(7)
    s_lshl2_add_u32 s82, s67, s0
    buffer_load_dwordx4 v[200:203], v1, s[56:59], s82 offen offset:0 sc1
    s_waitcnt vmcnt(7)
    s_add_u32 m0, s81, 16384
    s_lshr_b32 s27, s77, 11
    s_mul_i32 s27, s27, 458752
    s_bitcmp1_b32 s77, 10
    s_cselect_b32 s82, 57344, 0
    s_add_u32 s27, s27, s82
    s_add_u32 s27, s27, s5
    buffer_load_dwordx4 v4, s[48:51], s27 offen offset:0  lds
    s_waitcnt vmcnt(7)
    buffer_load_dwordx4 v5, s[48:51], s27 offen offset:1024  lds
    s_waitcnt vmcnt(7)
    buffer_load_dwordx4 v6, s[48:51], s27 offen offset:2048  lds
    s_waitcnt vmcnt(7)
    buffer_load_dwordx4 v7, s[48:51], s27 offen offset:3072  lds
    ds_read_b64_tr_b16 a[32:33], v8 offset:4096
    ds_read_b64_tr_b16 a[34:35], v8 offset:6144
    ds_read_b64_tr_b16 a[36:37], v9 offset:4096
    ds_read_b64_tr_b16 a[38:39], v9 offset:6144
    ds_read_b64_tr_b16 a[40:41], v10 offset:4096
    ds_read_b64_tr_b16 a[42:43], v10 offset:6144
    ds_read_b64_tr_b16 a[44:45], v11 offset:4096
    ds_read_b64_tr_b16 a[46:47], v11 offset:6144
    s_waitcnt vmcnt(7)
    s_add_u32 m0, s81, 20480
    s_lshr_b32 s27, s75, 11
    s_mul_i32 s27, s27, 458752
    s_bitcmp1_b32 s75, 10
    s_cselect_b32 s82, 57344, 0
    s_add_u32 s27, s27, s82
    s_add_u32 s27, s27, s5
    s_xor_b32 s27, s27, 128
    buffer_load_dwordx4 v4, s[48:51], s27 offen offset:0  lds
    s_waitcnt vmcnt(7)
    buffer_load_dwordx4 v5, s[48:51], s27 offen offset:1024  lds
    v_xor_b32 v168, s44, v168
    v_xor_b32 v169, s45, v169
    v_xor_b32 v170, s46, v170
    v_xor_b32 v171, s47, v171
    v_or3_b32 v13, v168, v169, v170
    v_or_b32 v13, v13, v171
    v_and_b32 v13, s1, v13
    v_cmp_ne_u32 vcc, 0, v13
    v_lshrrev_b32 v97, 4, v168
    v_and_b32 v96, 0x07070707, v168
    v_lshrrev_b32 v99, 4, v169
    v_and_b32 v98, 0x07070707, v169
    v_lshrrev_b32 v101, 4, v170
    v_and_b32 v100, 0x07070707, v170
    v_lshrrev_b32 v103, 4, v171
    v_and_b32 v102, 0x07070707, v171
    v_and_b32 v97, 0x07070707, v97
    v_and_b32 v99, 0x07070707, v99
    v_and_b32 v101, 0x07070707, v101
    v_and_b32 v103, 0x07070707, v103
    s_cbranch_vccnz dqs2
dqf2:
    v_perm_b32 v161, v17, v16, v96
    v_perm_b32 v104, v19, v18, v96
    v_perm_b32 v165, v21, v20, v98
    v_perm_b32 v105, v23, v22, v98
    v_perm_b32 v169, v25, v24, v100
    v_perm_b32 v106, v27, v26, v100
    v_perm_b32 v173, v29, v28, v102
    v_perm_b32 v107, v31, v30, v102
    v_perm_b32 v160, v104, v161, s6
    v_perm_b32 v161, v104, v161, s7
    v_perm_b32 v164, v105, v165, s6
    v_perm_b32 v165, v105, v165, s7
    v_perm_b32 v168, v106, v169, s6
    v_perm_b32 v169, v106, v169, s7
    v_perm_b32 v172, v107, v173, s6
    v_perm_b32 v173, v107, v173, s7
    v_perm_b32 v163, v17, v16, v97
    v_perm_b32 v108, v19, v18, v97
    v_perm_b32 v167, v21, v20, v99
    v_perm_b32 v109, v23, v22, v99
    v_perm_b32 v171, v25, v24, v101
    v_perm_b32 v110, v27, v26, v101
    v_perm_b32 v175, v29, v28, v103
    v_perm_b32 v111, v31, v30, v103
    v_perm_b32 v162, v108, v163, s6
    v_perm_b32 v163, v108, v163, s7
    v_perm_b32 v166, v109, v167, s6
    v_perm_b32 v167, v109, v167, s7
    v_perm_b32 v170, v110, v171, s6
    v_perm_b32 v171, v110, v171, s7
    v_perm_b32 v174, v111, v175, s6
    v_perm_b32 v175, v111, v175, s7
dqr2:
    s_waitcnt vmcnt(7)
    buffer_load_dwordx4 v6, s[48:51], s27 offen offset:2048  lds
    v_xor_b32 v184, s44, v184
    v_xor_b32 v185, s45, v185
    v_xor_b32 v186, s46, v186
    v_xor_b32 v187, s47, v187
    v_or3_b32 v13, v184, v185, v186
    v_or_b32 v13, v13, v187
    v_and_b32 v13, s1, v13
    v_cmp_ne_u32 vcc, 0, v13
    v_lshrrev_b32 v113, 4, v184
    v_and_b32 v112, 0x07070707, v184
    v_lshrrev_b32 v115, 4, v185
    v_and_b32 v114, 0x07070707, v185
    v_lshrrev_b32 v117, 4, v186
    v_and_b32 v116, 0x07070707, v186
    v_lshrrev_b32 v119, 4, v187
    v_and_b32 v118, 0x07070707, v187
    v_and_b32 v113, 0x07070707, v113
    v_and_b32 v115, 0x07070707, v115
    v_and_b32 v117, 0x07070707, v117
    v_and_b32 v119, 0x07070707, v119
    s_cbranch_vccnz dqs3
dqf3:
    v_perm_b32 v177, v17, v16, v112
    v_perm_b32 v120, v19, v18, v112
    v_perm_b32 v181, v21, v20, v114
    v_perm_b32 v121, v23, v22, v114
    v_perm_b32 v185, v25, v24, v116
    v_perm_b32 v122, v27, v26, v116
    v_perm_b32 v189, v29, v28, v118
    v_perm_b32 v123, v31, v30, v118
    v_perm_b32 v176, v120, v177, s6
    v_perm_b32 v177, v120, v177, s7
    v_perm_b32 v180, v121, v181, s6
    v_perm_b32 v181, v121, v181, s7
    v_perm_b32 v184, v122, v185, s6
    v_perm_b32 v185, v122, v185, s7
    v_perm_b32 v188, v123, v189, s6
    v_perm_b32 v189, v123, v189, s7
    v_perm_b32 v179, v17, v16, v113
    v_perm_b32 v124, v19, v18, v113
    v_perm_b32 v183, v21, v20, v115
    v_perm_b32 v125, v23, v22, v115
    v_perm_b32 v187, v25, v24, v117
    v_perm_b32 v126, v27, v26, v117
    v_perm_b32 v191, v29, v28, v119
    v_perm_b32 v127, v31, v30, v119
    v_perm_b32 v178, v124, v179, s6
    v_perm_b32 v179, v124, v179, s7
    v_perm_b32 v182, v125, v183, s6
    v_perm_b32 v183, v125, v183, s7
    v_perm_b32 v186, v126, v187, s6
    v_perm_b32 v187, v126, v187, s7
    v_perm_b32 v190, v127, v191, s6
    v_perm_b32 v191, v127, v191, s7
dqr3:
    s_waitcnt vmcnt(7)
    buffer_load_dwordx4 v7, s[48:51], s27 offen offset:3072  lds
    v_xor_b32 v200, s44, v200
    v_xor_b32 v201, s45, v201
    v_xor_b32 v202, s46, v202
    v_xor_b32 v203, s47, v203
    v_or3_b32 v13, v200, v201, v202
    v_or_b32 v13, v13, v203
    v_and_b32 v13, s1, v13
    v_cmp_ne_u32 vcc, 0, v13
    v_lshrrev_b32 v97, 4, v200
    v_and_b32 v96, 0x07070707, v200
    v_lshrrev_b32 v99, 4, v201
    v_and_b32 v98, 0x07070707, v201
    v_lshrrev_b32 v101, 4, v202
    v_and_b32 v100, 0x07070707, v202
    v_lshrrev_b32 v103, 4, v203
    v_and_b32 v102, 0x07070707, v203
    v_and_b32 v97, 0x07070707, v97
    v_and_b32 v99, 0x07070707, v99
    v_and_b32 v101, 0x07070707, v101
    v_and_b32 v103, 0x07070707, v103
    s_cbranch_vccnz dqs4
dqf4:
    v_perm_b32 v193, v17, v16, v96
    v_perm_b32 v104, v19, v18, v96
    v_perm_b32 v197, v21, v20, v98
    v_perm_b32 v105, v23, v22, v98
    v_perm_b32 v201, v25, v24, v100
    v_perm_b32 v106, v27, v26, v100
    v_perm_b32 v205, v29, v28, v102
    v_perm_b32 v107, v31, v30, v102
    v_perm_b32 v192, v104, v193, s6
    v_perm_b32 v193, v104, v193, s7
    v_perm_b32 v196, v105, v197, s6
    v_perm_b32 v197, v105, v197, s7
    v_perm_b32 v200, v106, v201, s6
    v_perm_b32 v201, v106, v201, s7
    v_perm_b32 v204, v107, v205, s6
    v_perm_b32 v205, v107, v205, s7
    v_perm_b32 v195, v17, v16, v97
    v_perm_b32 v108, v19, v18, v97
    v_perm_b32 v199, v21, v20, v99
    v_perm_b32 v109, v23, v22, v99
    v_perm_b32 v203, v25, v24, v101
    v_perm_b32 v110, v27, v26, v101
    v_perm_b32 v207, v29, v28, v103
    v_perm_b32 v111, v31, v30, v103
    v_perm_b32 v194, v108, v195, s6
    v_perm_b32 v195, v108, v195, s7
    v_perm_b32 v198, v109, v199, s6
    v_perm_b32 v199, v109, v199, s7
    v_perm_b32 v202, v110, v203, s6
    v_perm_b32 v203, v110, v203, s7
    v_perm_b32 v206, v111, v207, s6
    v_perm_b32 v207, v111, v207, s7
dqr4:
    ds_read_b64_tr_b16 a[64:65], v8 offset:8192
    ds_read_b64_tr_b16 a[66:67], v8 offset:10240
    ds_read_b64_tr_b16 a[68:69], v9 offset:8192
    ds_read_b64_tr_b16 a[70:71], v9 offset:10240
    ds_read_b64_tr_b16 a[72:73], v10 offset:8192
    ds_read_b64_tr_b16 a[74:75], v10 offset:10240
    ds_read_b64_tr_b16 a[76:77], v11 offset:8192
    ds_read_b64_tr_b16 a[78:79], v11 offset:10240
    s_waitcnt vmcnt(7)
    s_lshl2_add_u32 s82, s65, s0
    buffer_load_dwordx4 v[216:219], v1, s[56:59], s82 offen offset:2048 sc1
    s_waitcnt vmcnt(7)
    s_lshl2_add_u32 s82, s66, s0
    buffer_load_dwordx4 v[232:235], v1, s[56:59], s82 offen offset:2048 sc1
    s_waitcnt vmcnt(7)
    s_lshl2_add_u32 s82, s67, s0
    buffer_load_dwordx4 v[248:251], v1, s[56:59], s82 offen offset:2048 sc1
    s_waitcnt vmcnt(7)
    s_lshl2_add_u32 s83, s69, s68
    s_lshl_b32 s83, s83, 7
    s_add_u32 s70, s83, 3145728
    s_mov_b64 exec, 0xff
    buffer_load_dwordx2 v[2:3], v0, s[56:59], s70 offen sc1
    s_mov_b64 exec, -1
    s_waitcnt vmcnt(7)
    s_waitcnt lgkmcnt(15)
    s_add_u32 m0, s81, 0
    s_lshr_b32 s27, s76, 11
    s_mul_i32 s27, s27, 458752
    s_bitcmp1_b32 s76, 10
    s_cselect_b32 s82, 57344, 0
    s_add_u32 s27, s27, s82
    s_add_u32 s27, s27, s5
    s_xor_b32 s27, s27, 128
    buffer_load_dwordx4 v4, s[48:51], s27 offen offset:0  lds
    s_waitcnt vmcnt(7)
    buffer_load_dwordx4 v5, s[48:51], s27 offen offset:1024  lds
    s_waitcnt vmcnt(7)
    buffer_load_dwordx4 v6, s[48:51], s27 offen offset:2048  lds
    s_waitcnt vmcnt(7)
    buffer_load_dwordx4 v7, s[48:51], s27 offen offset:3072  lds
    ds_read_b64_tr_b16 a[16:17], v8 offset:12288
    ds_read_b64_tr_b16 a[18:19], v8 offset:14336
    ds_read_b64_tr_b16 a[20:21], v9 offset:12288
    ds_read_b64_tr_b16 a[22:23], v9 offset:14336
    ds_read_b64_tr_b16 a[24:25], v10 offset:12288
    ds_read_b64_tr_b16 a[26:27], v10 offset:14336
    ds_read_b64_tr_b16 a[28:29], v11 offset:12288
    ds_read_b64_tr_b16 a[30:31], v11 offset:14336
    s_waitcnt vmcnt(7)
    s_waitcnt lgkmcnt(15)
    s_add_u32 m0, s81, 4096
    s_lshr_b32 s27, s77, 11
    s_mul_i32 s27, s27, 458752
    s_bitcmp1_b32 s77, 10
    s_cselect_b32 s82, 57344, 0
    s_add_u32 s27, s27, s82
    s_add_u32 s27, s27, s5
    s_xor_b32 s27, s27, 128
    buffer_load_dwordx4 v4, s[48:51], s27 offen offset:0  lds
    v_xor_b32 v216, s44, v216
    v_xor_b32 v217, s45, v217
    v_xor_b32 v218, s46, v218
    v_xor_b32 v219, s47, v219
    v_or3_b32 v13, v216, v217, v218
    v_or_b32 v13, v13, v219
    v_and_b32 v13, s1, v13
    v_cmp_ne_u32 vcc, 0, v13
    v_lshrrev_b32 v113, 4, v216
    v_and_b32 v112, 0x07070707, v216
    v_lshrrev_b32 v115, 4, v217
    v_and_b32 v114, 0x07070707, v217
    v_lshrrev_b32 v117, 4, v218
    v_and_b32 v116, 0x07070707, v218
    v_lshrrev_b32 v119, 4, v219
    v_and_b32 v118, 0x07070707, v219
    v_and_b32 v113, 0x07070707, v113
    v_and_b32 v115, 0x07070707, v115
    v_and_b32 v117, 0x07070707, v117
    v_and_b32 v119, 0x07070707, v119
    s_cbranch_vccnz dqs5
dqf5:
    v_perm_b32 v209, v17, v16, v112
    v_perm_b32 v120, v19, v18, v112
    v_perm_b32 v213, v21, v20, v114
    v_perm_b32 v121, v23, v22, v114
    v_perm_b32 v217, v25, v24, v116
    v_perm_b32 v122, v27, v26, v116
    v_perm_b32 v221, v29, v28, v118
    v_perm_b32 v123, v31, v30, v118
    v_perm_b32 v208, v120, v209, s6
    v_perm_b32 v209, v120, v209, s7
    v_perm_b32 v212, v121, v213, s6
    v_perm_b32 v213, v121, v213, s7
    v_perm_b32 v216, v122, v217, s6
    v_perm_b32 v217, v122, v217, s7
    v_perm_b32 v220, v123, v221, s6
    v_perm_b32 v221, v123, v221, s7
    v_perm_b32 v211, v17, v16, v113
    v_perm_b32 v124, v19, v18, v113
    v_perm_b32 v215, v21, v20, v115
    v_perm_b32 v125, v23, v22, v115
    v_perm_b32 v219, v25, v24, v117
    v_perm_b32 v126, v27, v26, v117
    v_perm_b32 v223, v29, v28, v119
    v_perm_b32 v127, v31, v30, v119
    v_perm_b32 v210, v124, v211, s6
    v_perm_b32 v211, v124, v211, s7
    v_perm_b32 v214, v125, v215, s6
    v_perm_b32 v215, v125, v215, s7
    v_perm_b32 v218, v126, v219, s6
    v_perm_b32 v219, v126, v219, s7
    v_perm_b32 v222, v127, v223, s6
    v_perm_b32 v223, v127, v223, s7
dqr5:
    s_waitcnt vmcnt(7)
    buffer_load_dwordx4 v5, s[48:51], s27 offen offset:1024  lds
    v_xor_b32 v232, s44, v232
    v_xor_b32 v233, s45, v233
    v_xor_b32 v234, s46, v234
    v_xor_b32 v235, s47, v235
    v_or3_b32 v13, v232, v233, v234
    v_or_b32 v13, v13, v235
    v_and_b32 v13, s1, v13
    v_cmp_ne_u32 vcc, 0, v13
    v_lshrrev_b32 v97, 4, v232
    v_and_b32 v96, 0x07070707, v232
    v_lshrrev_b32 v99, 4, v233
    v_and_b32 v98, 0x07070707, v233
    v_lshrrev_b32 v101, 4, v234
    v_and_b32 v100, 0x07070707, v234
    v_lshrrev_b32 v103, 4, v235
    v_and_b32 v102, 0x07070707, v235
    v_and_b32 v97, 0x07070707, v97
    v_and_b32 v99, 0x07070707, v99
    v_and_b32 v101, 0x07070707, v101
    v_and_b32 v103, 0x07070707, v103
    s_cbranch_vccnz dqs6
dqf6:
    v_perm_b32 v225, v17, v16, v96
    v_perm_b32 v104, v19, v18, v96
    v_perm_b32 v229, v21, v20, v98
    v_perm_b32 v105, v23, v22, v98
    v_perm_b32 v233, v25, v24, v100
    v_perm_b32 v106, v27, v26, v100
    v_perm_b32 v237, v29, v28, v102
    v_perm_b32 v107, v31, v30, v102
    v_perm_b32 v224, v104, v225, s6
    v_perm_b32 v225, v104, v225, s7
    v_perm_b32 v228, v105, v229, s6
    v_perm_b32 v229, v105, v229, s7
    v_perm_b32 v232, v106, v233, s6
    v_perm_b32 v233, v106, v233, s7
    v_perm_b32 v236, v107, v237, s6
    v_perm_b32 v237, v107, v237, s7
    v_perm_b32 v227, v17, v16, v97
    v_perm_b32 v108, v19, v18, v97
    v_perm_b32 v231, v21, v20, v99
    v_perm_b32 v109, v23, v22, v99
    v_perm_b32 v235, v25, v24, v101
    v_perm_b32 v110, v27, v26, v101
    v_perm_b32 v239, v29, v28, v103
    v_perm_b32 v111, v31, v30, v103
    v_perm_b32 v226, v108, v227, s6
    v_perm_b32 v227, v108, v227, s7
    v_perm_b32 v230, v109, v231, s6
    v_perm_b32 v231, v109, v231, s7
    v_perm_b32 v234, v110, v235, s6
    v_perm_b32 v235, v110, v235, s7
    v_perm_b32 v238, v111, v239, s6
    v_perm_b32 v239, v111, v239, s7
dqr6:
    s_waitcnt vmcnt(7)
    buffer_load_dwordx4 v6, s[48:51], s27 offen offset:2048  lds
    v_xor_b32 v248, s44, v248
    v_xor_b32 v249, s45, v249
    v_xor_b32 v250, s46, v250
    v_xor_b32 v251, s47, v251
    v_or3_b32 v13, v248, v249, v250
    v_or_b32 v13, v13, v251
    v_and_b32 v13, s1, v13
    v_cmp_ne_u32 vcc, 0, v13
    v_lshrrev_b32 v113, 4, v248
    v_and_b32 v112, 0x07070707, v248
    v_lshrrev_b32 v115, 4, v249
    v_and_b32 v114, 0x07070707, v249
    v_lshrrev_b32 v117, 4, v250
    v_and_b32 v116, 0x07070707, v250
    v_lshrrev_b32 v119, 4, v251
    v_and_b32 v118, 0x07070707, v251
    v_and_b32 v113, 0x07070707, v113
    v_and_b32 v115, 0x07070707, v115
    v_and_b32 v117, 0x07070707, v117
    v_and_b32 v119, 0x07070707, v119
    s_cbranch_vccnz dqs7
dqf7:
    v_perm_b32 v241, v17, v16, v112
    v_perm_b32 v120, v19, v18, v112
    v_perm_b32 v245, v21, v20, v114
    v_perm_b32 v121, v23, v22, v114
    v_perm_b32 v249, v25, v24, v116
    v_perm_b32 v122, v27, v26, v116
    v_perm_b32 v253, v29, v28, v118
    v_perm_b32 v123, v31, v30, v118
    v_perm_b32 v240, v120, v241, s6
    v_perm_b32 v241, v120, v241, s7
    v_perm_b32 v244, v121, v245, s6
    v_perm_b32 v245, v121, v245, s7
    v_perm_b32 v248, v122, v249, s6
    v_perm_b32 v249, v122, v249, s7
    v_perm_b32 v252, v123, v253, s6
    v_perm_b32 v253, v123, v253, s7
    v_perm_b32 v243, v17, v16, v113
    v_perm_b32 v124, v19, v18, v113
    v_perm_b32 v247, v21, v20, v115
    v_perm_b32 v125, v23, v22, v115
    v_perm_b32 v251, v25, v24, v117
    v_perm_b32 v126, v27, v26, v117
    v_perm_b32 v255, v29, v28, v119
    v_perm_b32 v127, v31, v30, v119
    v_perm_b32 v242, v124, v243, s6
    v_perm_b32 v243, v124, v243, s7
    v_perm_b32 v246, v125, v247, s6
    v_perm_b32 v247, v125, v247, s7
    v_perm_b32 v250, v126, v251, s6
    v_perm_b32 v251, v126, v251, s7
    v_perm_b32 v254, v127, v255, s6
    v_perm_b32 v255, v127, v255, s7
dqr7:
    s_waitcnt vmcnt(7)
    buffer_load_dwordx4 v7, s[48:51], s27 offen offset:3072  lds
    ds_read_b64_tr_b16 a[96:97], v8 offset:16384
    ds_read_b64_tr_b16 a[98:99], v8 offset:18432
    ds_read_b64_tr_b16 a[100:101], v9 offset:16384
    ds_read_b64_tr_b16 a[102:103], v9 offset:18432
    ds_read_b64_tr_b16 a[104:105], v10 offset:16384
    ds_read_b64_tr_b16 a[106:107], v10 offset:18432
    ds_read_b64_tr_b16 a[108:109], v11 offset:16384
    ds_read_b64_tr_b16 a[110:111], v11 offset:18432
    s_mov_b64 exec, 0xff
    s_mov_b32 s85, 30000
pl_3:
    v_cmp_ne_u64 vcc, s[72:73], v[2:3]
    s_cbranch_vccz po_4
    s_sub_u32 s85, s85, 1
    s_cbranch_scc1 po_4
    buffer_load_dwordx2 v[2:3], v0, s[56:59], s70 offen sc1
    s_waitcnt vmcnt(0)
    s_branch pl_3
po_4:
    s_mov_b64 exec, -1
    v_bfe_u32 v14, v0, 5, 3
    v_bfe_u32 v15, v0, 3, 2
    v_lshl_add_u32 v14, v15, 5, v14
    s_lshl_b32 s82, s69, 4
    s_add_u32 s82, s82, s68
    s_lshl_b32 s82, s82, 13
    v_lshlrev_b32 v14, 10, v14
    v_add_u32 v3, s82, v14
    v_add_u32 v66, s30, v1
    v_add_u32 v67, s31, v1
    v_add_u32 v65, s29, v1
    v_add_u32 v64, s28, v1
    buffer_load_dword v2, v3, s[56:59], 0 offen sc1
    buffer_load_dwordx4 a[224:227], v67, s[56:59], s64 offen offset:0 sc1
    buffer_load_dwordx4 a[228:231], v67, s[56:59], s65 offen offset:0 sc1
    buffer_load_dwordx4 a[232:235], v67, s[56:59], s66 offen offset:0 sc1
    buffer_load_dwordx4 a[236:239], v67, s[56:59], s67 offen offset:0 sc1
    buffer_load_dwordx4 a[240:243], v67, s[56:59], s64 offen offset:2048 sc1
    buffer_load_dwordx4 a[244:247], v67, s[56:59], s65 offen offset:2048 sc1
    buffer_load_dwordx4 a[248:251], v67, s[56:59], s66 offen offset:2048 sc1
    buffer_load_dwordx4 a[252:255], v67, s[56:59], s67 offen offset:2048 sc1
    v_add_u32 v24, s81, v1
    s_xor_b32 s82, s68, 1
    s_mul_i32 s82, s82, 40960
    v_add_u32 v25, s82, v1
    s_xor_b32 s82, s68, 2
    s_mul_i32 s82, s82, 40960
    v_add_u32 v26, s82, v1
    s_xor_b32 s82, s68, 3
    s_mul_i32 s82, s82, 40960
    v_add_u32 v27, s82, v1
    s_and_b32 s83, s4, 1
    s_lshl_b32 s83, s83, 3
    s_lshr_b32 s82, s68, 1
    s_add_u32 s83, s83, s82
    s_xor_b32 s82, s3, 2
    s_and_b32 s82, s82, 3
    s_lshl1_add_u32 s82, s82, s83
    s_mul_i32 s84, s82, 114688
    s_add_u32 s84, s84, 1048576
    v_add_u32 v16, s84, v1
    s_xor_b32 s82, s82, 1
    s_mul_i32 s84, s82, 114688
    s_add_u32 s84, s84, 1048576
    v_add_u32 v17, s84, v1
    s_xor_b32 s82, s3, 1
    s_and_b32 s82, s82, 3
    s_lshl1_add_u32 s82, s82, s83
    s_mul_i32 s84, s82, 114688
    s_add_u32 s84, s84, 1048576
    v_add_u32 v18, s84, v1
    s_xor_b32 s82, s82, 1
    s_mul_i32 s84, s82, 114688
    s_add_u32 s84, s84, 1048576
    v_add_u32 v19, s84, v1
    s_xor_b32 s82, s3, 3
    s_and_b32 s82, s82, 3
    s_lshl1_add_u32 s82, s82, s83
    s_mul_i32 s84, s82, 114688
    s_add_u32 s84, s84, 1048576
    v_add_u32 v20, s84, v1
    s_xor_b32 s82, s82, 1
    s_mul_i32 s84, s82, 114688
    s_add_u32 s84, s84, 1048576
    v_add_u32 v21, s84, v1
    s_xor_b32 s82, s3, 0
    s_and_b32 s82, s82, 3
    s_lshl1_add_u32 s82, s82, s83
    s_mul_i32 s84, s82, 114688
    s_add_u32 s84, s84, 1048576
    v_add_u32 v22, s84, v1
    s_xor_b32 s82, s82, 1
    s_mul_i32 s84, s82, 114688
    s_add_u32 s84, s84, 1048576
    v_add_u32 v23, s84, v1
    v_bfe_u32 v14, v0, 3, 4
    v_lshrrev_b32 v15, 7, v0
    v_mul_u32_u24 v28, 7168, v14
    v_lshl_add_u32 v28, v15, 4, v28
    v_bfe_u32 v14, v0, 3, 1
    s_xor_b32 s82, s3, 2
    s_and_b32 s82, s82, 3
    s_lshl_b32 s82, s82, 1
    v_add_u32 v14, s82, v14
    v_lshrrev_b32 v15, 6, v0
    v_min_u32 v15, 6, v15
    v_mul_u32_u24 v14, 112, v14
    v_add_u32 v14, v14, v15
    s_lshl2_add_u32 s82, s3, s68
    s_mul_i32 s82, s82, 7
    s_bitcmp1_b32 s4, 0
    s_cselect_b32 s83, 896, 0
    s_add_u32 s82, s82, s83
    s_add_u32 s82, s82, 1024
    v_add_u32 v14, s82, v14
    v_lshlrev_b32 v29, 10, v14
    s_lshr_b32 s32, s74, 11
    s_mul_i32 s32, s32, 458752
    s_bitcmp1_b32 s74, 10
    s_cselect_b32 s82, 57344, 0
    s_add_u32 s32, s32, s82
    s_add_u32 s32, s32, s5
    s_lshr_b32 s33, s75, 11
    s_mul_i32 s33, s33, 458752
    s_bitcmp1_b32 s75, 10
    s_cselect_b32 s82, 57344, 0
    s_add_u32 s33, s33, s82
    s_add_u32 s33, s33, s5
    s_lshr_b32 s34, s76, 11
    s_mul_i32 s34, s34, 458752
    s_bitcmp1_b32 s76, 10
    s_cselect_b32 s82, 57344, 0
    s_add_u32 s34, s34, s82
    s_add_u32 s34, s34, s5
    s_lshr_b32 s35, s77, 11
    s_mul_i32 s35, s35, 458752
    s_bitcmp1_b32 s77, 10
    s_cselect_b32 s82, 57344, 0
    s_add_u32 s35, s35, s82
    s_add_u32 s35, s35, s5
    s_lshr_b32 s44, s78, 11
    s_mul_i32 s44, s44, 458752
    s_bitcmp1_b32 s78, 10
    s_cselect_b32 s82, 57344, 0
    s_add_u32 s44, s44, s82
    s_add_u32 s44, s44, s5
    s_lshr_b32 s45, s79, 11
    s_mul_i32 s45, s45, 458752
    s_bitcmp1_b32 s79, 10
    s_cselect_b32 s82, 57344, 0
    s_add_u32 s45, s45, s82
    s_add_u32 s45, s45, s5
    s_lshr_b32 s46, s80, 11
    s_mul_i32 s46, s46, 458752
    s_bitcmp1_b32 s80, 10
    s_cselect_b32 s82, 57344, 0
    s_add_u32 s46, s46, s82
    s_add_u32 s46, s46, s5
    v_add_u32 v68, 24576, v24
    v_add_u32 v69, 26624, v24
    v_add_u32 v70, 28672, v24
    v_add_u32 v71, 30720, v24
    v_add_u32 v72, 32768, v24
    v_add_u32 v73, 34816, v24
    s_lshr_b32 s36, s3, 1
    s_xor_b32 s36, s36, s3
    s_xor_b32 s36, s36, s69
    s_lshl_b32 s36, s36, 1
    s_xor_b32 s36, s36, s68
    s_and_b32 s36, s36, 2
    s_xor_b32 s36, s36, s68
    s_xor_b32 s36, s36, 2
    s_lshl2_add_u32 s36, s69, s36
    s_mul_i32 s36, s36, 56
    s_add_u32 s36, s36, s71
    s_lshr_b32 s82, s68, 1
    s_lshl1_add_u32 s36, s36, s82
    s_lshl_b32 s36, s36, 10
    s_add_u32 s36, s36, 1048576
    s_lshr_b32 s37, s3, 1
    s_xor_b32 s37, s37, s3
    s_xor_b32 s37, s37, s69
    s_lshl_b32 s37, s37, 1
    s_xor_b32 s37, s37, s68
    s_and_b32 s37, s37, 2
    s_xor_b32 s37, s37, s68
    s_lshl2_add_u32 s37, s69, s37
    s_mul_i32 s37, s37, 56
    s_add_u32 s37, s37, s71
    s_lshr_b32 s82, s68, 1
    s_lshl1_add_u32 s37, s37, s82
    s_lshl_b32 s37, s37, 10
    s_add_u32 s37, s37, 1048576
    ds_read_b64_tr_b16 a[48:49], v8 offset:20480
    ds_read_b64_tr_b16 a[50:51], v8 offset:22528
    ds_read_b64_tr_b16 a[52:53], v9 offset:20480
    ds_read_b64_tr_b16 a[54:55], v9 offset:22528
    ds_read_b64_tr_b16 a[56:57], v10 offset:20480
    ds_read_b64_tr_b16 a[58:59], v10 offset:22528
    ds_read_b64_tr_b16 a[60:61], v11 offset:20480
    ds_read_b64_tr_b16 a[62:63], v11 offset:22528
    s_waitcnt vmcnt(13)
    ds_read_b64_tr_b16 a[80:81], v8 offset:0
    ds_read_b64_tr_b16 a[82:83], v8 offset:2048
    ds_read_b64_tr_b16 a[84:85], v9 offset:0
    ds_read_b64_tr_b16 a[86:87], v9 offset:2048
    ds_read_b64_tr_b16 a[88:89], v10 offset:0
    ds_read_b64_tr_b16 a[90:91], v10 offset:2048
    ds_read_b64_tr_b16 a[92:93], v11 offset:0
    ds_read_b64_tr_b16 a[94:95], v11 offset:2048
    s_waitcnt vmcnt(9)
    ds_read_b64_tr_b16 a[112:113], v8 offset:4096
    ds_read_b64_tr_b16 a[114:115], v8 offset:6144
    ds_read_b64_tr_b16 a[116:117], v9 offset:4096
    ds_read_b64_tr_b16 a[118:119], v9 offset:6144
    ds_read_b64_tr_b16 a[120:121], v10 offset:4096
    ds_read_b64_tr_b16 a[122:123], v10 offset:6144
    ds_read_b64_tr_b16 a[124:125], v11 offset:4096
    ds_read_b64_tr_b16 a[126:127], v11 offset:6144
    s_mov_b32 s85, 30000
gt_5:
    s_waitcnt vmcnt(8)
    v_cmp_eq_u32 vcc, -1, v2
    s_cbranch_vccz gt_5o
    s_sub_u32 s85, s85, 1
    s_cbranch_scc1 gt_5o
    buffer_load_dword v2, v3, s[56:59], 0 offen sc1
    buffer_load_dwordx4 a[224:227], v67, s[56:59], s64 offen offset:0 sc1
    buffer_load_dwordx4 a[228:231], v67, s[56:59], s65 offen offset:0 sc1
    buffer_load_dwordx4 a[232:235], v67, s[56:59], s66 offen offset:0 sc1
    buffer_load_dwordx4 a[236:239], v67, s[56:59], s67 offen offset:0 sc1
    buffer_load_dwordx4 a[240:243], v67, s[56:59], s64 offen offset:2048 sc1
    buffer_load_dwordx4 a[244:247], v67, s[56:59], s65 offen offset:2048 sc1
    buffer_load_dwordx4 a[248:251], v67, s[56:59], s66 offen offset:2048 sc1
    buffer_load_dwordx4 a[252:255], v67, s[56:59], s67 offen offset:2048 sc1
    s_branch gt_5
gt_5o:
    buffer_load_dwordx4 v[96:99], v66, s[56:59], s64 offen offset:0 sc1
    buffer_load_dwordx4 v[100:103], v66, s[56:59], s65 offen offset:0 sc1
    buffer_load_dwordx4 v[104:107], v66, s[56:59], s66 offen offset:0 sc1
    buffer_load_dwordx4 v[108:111], v66, s[56:59], s67 offen offset:0 sc1
    buffer_load_dwordx4 v[112:115], v66, s[56:59], s64 offen offset:2048 sc1
    buffer_load_dwordx4 v[116:119], v66, s[56:59], s65 offen offset:2048 sc1
    buffer_load_dwordx4 v[120:123], v66, s[56:59], s66 offen offset:2048 sc1
    buffer_load_dwordx4 v[124:127], v66, s[56:59], s67 offen offset:2048 sc1
    buffer_load_dwordx4 a[192:195], v65, s[56:59], s64 offen offset:0 sc1
    buffer_load_dwordx4 a[196:199], v65, s[56:59], s65 offen offset:0 sc1
    buffer_load_dwordx4 a[200:203], v65, s[56:59], s66 offen offset:0 sc1
    buffer_load_dwordx4 a[204:207], v65, s[56:59], s67 offen offset:0 sc1
    s_waitcnt vmcnt(16)
    v_accvgpr_read_b32 v14, a224
    v_accvgpr_read_b32 v15, a228
    v_accvgpr_read_b32 v13, a232
    v_max3_u32 v13, v14, v15, v13
    v_accvgpr_read_b32 v14, a236
    v_max_u32 v13, v13, v14
    v_cmp_eq_u32 vcc, -1, v13
    s_cbranch_vccnz ck_6s
ck_6r:
    v_mfma_f32_16x16x32_bf16 v[32:35], v[128:131], a[224:227], 0
    v_mfma_f32_16x16x32_bf16 v[36:39], v[132:135], a[224:227], 0
    v_mfma_f32_16x16x32_bf16 v[40:43], v[136:139], a[224:227], 0
    v_mfma_f32_16x16x32_bf16 v[44:47], v[140:143], a[224:227], 0
    buffer_load_dwordx4 a[144:147], v65, s[56:59], s64 offen offset:2048 sc1
    v_mfma_f32_16x16x32_bf16 v[32:35], v[160:163], a[228:231], v[32:35]
    v_mfma_f32_16x16x32_bf16 v[36:39], v[164:167], a[228:231], v[36:39]
    v_mfma_f32_16x16x32_bf16 v[40:43], v[168:171], a[228:231], v[40:43]
    buffer_load_dwordx4 a[148:151], v65, s[56:59], s65 offen offset:2048 sc1
    v_mfma_f32_16x16x32_bf16 v[44:47], v[172:175], a[228:231], v[44:47]
    v_mfma_f32_16x16x32_bf16 v[32:35], v[176:179], a[232:235], v[32:35]
    v_mfma_f32_16x16x32_bf16 v[36:39], v[180:183], a[232:235], v[36:39]
    buffer_load_dwordx4 a[152:155], v65, s[56:59], s66 offen offset:2048 sc1
    v_mfma_f32_16x16x32_bf16 v[40:43], v[184:187], a[232:235], v[40:43]
    s_waitcnt vmcnt(15)
    v_accvgpr_read_b32 v14, a240
    v_accvgpr_read_b32 v15, a244
    v_mfma_f32_16x16x32_bf16 v[44:47], v[188:191], a[232:235], v[44:47]
    v_accvgpr_read_b32 v13, a248
    v_max3_u32 v13, v14, v15, v13
    v_mfma_f32_16x16x32_bf16 v[32:35], v[192:195], a[236:239], v[32:35]
    v_accvgpr_read_b32 v14, a252
    v_max_u32 v13, v13, v14
    v_mfma_f32_16x16x32_bf16 v[36:39], v[196:199], a[236:239], v[36:39]
    v_cmp_eq_u32 vcc, -1, v13
    s_cbranch_vccnz ck_7s
ck_7r:
    v_mfma_f32_16x16x32_bf16 v[40:43], v[200:203], a[236:239], v[40:43]
    buffer_load_dwordx4 a[156:159], v65, s[56:59], s67 offen offset:2048 sc1
    v_mfma_f32_16x16x32_bf16 v[44:47], v[204:207], a[236:239], v[44:47]
    v_mfma_f32_16x16x32_bf16 v[32:35], v[144:147], a[240:243], v[32:35]
    v_mfma_f32_16x16x32_bf16 v[36:39], v[148:151], a[240:243], v[36:39]
    buffer_load_dwordx4 a[176:179], v64, s[56:59], s64 offen offset:0 sc1
    v_mfma_f32_16x16x32_bf16 v[40:43], v[152:155], a[240:243], v[40:43]
    v_mfma_f32_16x16x32_bf16 v[44:47], v[156:159], a[240:243], v[44:47]
    v_mfma_f32_16x16x32_bf16 v[32:35], v[208:211], a[244:247], v[32:35]
    buffer_load_dwordx4 a[180:183], v64, s[56:59], s65 offen offset:0 sc1
    v_mfma_f32_16x16x32_bf16 v[36:39], v[212:215], a[244:247], v[36:39]
    v_mfma_f32_16x16x32_bf16 v[40:43], v[216:219], a[244:247], v[40:43]
    v_mfma_f32_16x16x32_bf16 v[44:47], v[220:223], a[244:247], v[44:47]
    buffer_load_dwordx4 a[184:187], v64, s[56:59], s66 offen offset:0 sc1
    v_mfma_f32_16x16x32_bf16 v[32:35], v[224:227], a[248:251], v[32:35]
    v_mfma_f32_16x16x32_bf16 v[36:39], v[228:231], a[248:251], v[36:39]
    v_mfma_f32_16x16x32_bf16 v[40:43], v[232:235], a[248:251], v[40:43]
    s_waitcnt vmcnt(15)
    v_max3_u32 v13, v96, v100, v104
    v_max_u32 v13, v13, v108
    v_mfma_f32_16x16x32_bf16 v[44:47], v[236:239], a[248:251], v[44:47]
    v_cmp_eq_u32 vcc, -1, v13
    s_cbranch_vccnz ck_8s
ck_8r:
    v_mfma_f32_16x16x32_bf16 v[32:35], v[240:243], a[252:255], v[32:35]
    buffer_load_dwordx4 a[188:191], v64, s[56:59], s67 offen offset:0 sc1
    v_mfma_f32_16x16x32_bf16 v[36:39], v[244:247], a[252:255], v[36:39]
    v_mfma_f32_16x16x32_bf16 v[40:43], v[248:251], a[252:255], v[40:43]
    v_mfma_f32_16x16x32_bf16 v[44:47], v[252:255], a[252:255], v[44:47]
    buffer_load_dwordx4 a[208:211], v64, s[56:59], s64 offen offset:2048 sc1
    v_mfma_f32_16x16x32_bf16 v[48:51], v[128:131], v[96:99], 0
    ds_write2_b64 v68, v[32:33], v[36:37] offset0:0 offset1:1
    v_mfma_f32_16x16x32_bf16 v[52:55], v[132:135], v[96:99], 0
    v_mfma_f32_16x16x32_bf16 v[56:59], v[136:139], v[96:99], 0
    buffer_load_dwordx4 a[212:215], v64, s[56:59], s65 offen offset:2048 sc1
    v_mfma_f32_16x16x32_bf16 v[60:63], v[140:143], v[96:99], 0
    ds_write2_b64 v68, v[40:41], v[44:45] offset0:128 offset1:129
    v_mfma_f32_16x16x32_bf16 v[48:51], v[160:163], v[100:103], v[48:51]
    v_mfma_f32_16x16x32_bf16 v[52:55], v[164:167], v[100:103], v[52:55]
    buffer_load_dwordx4 a[216:219], v64, s[56:59], s66 offen offset:2048 sc1
    v_mfma_f32_16x16x32_bf16 v[56:59], v[168:171], v[100:103], v[56:59]
    ds_write2_b64 v69, v[34:35], v[38:39] offset0:0 offset1:1
    v_mfma_f32_16x16x32_bf16 v[60:63], v[172:175], v[100:103], v[60:63]
    v_mfma_f32_16x16x32_bf16 v[48:51], v[176:179], v[104:107], v[48:51]
    buffer_load_dwordx4 a[220:223], v64, s[56:59], s67 offen offset:2048 sc1
    v_mfma_f32_16x16x32_bf16 v[52:55], v[180:183], v[104:107], v[52:55]
    ds_write2_b64 v69, v[42:43], v[46:47] offset0:128 offset1:129
    v_mfma_f32_16x16x32_bf16 v[56:59], v[184:187], v[104:107], v[56:59]
    s_waitcnt vmcnt(16)
    v_max3_u32 v13, v112, v116, v120
    v_max_u32 v13, v13, v124
    v_mfma_f32_16x16x32_bf16 v[60:63], v[188:191], v[104:107], v[60:63]
    v_cmp_eq_u32 vcc, -1, v13
    s_cbranch_vccnz ck_9s
ck_9r:
    v_mfma_f32_16x16x32_bf16 v[48:51], v[192:195], v[108:111], v[48:51]
    s_lshl2_add_u32 s83, s3, s68
    s_mul_i32 s83, s83, 7
    s_lshr_b32 s83, s83, 1
    s_bitcmp1_b32 s4, 0
    s_cselect_b32 s82, 56, 0
    s_add_u32 s83, s83, s82
    s_lshl_b32 s83, s83, 6
    s_add_u32 s70, s83, 3149824
    s_mov_b32 exec_hi, 0
    buffer_load_dwordx2 v[30:31], v0, s[56:59], s70 offen sc1
    s_mov_b64 exec, -1
    v_mfma_f32_16x16x32_bf16 v[52:55], v[196:199], v[108:111], v[52:55]
    v_mfma_f32_16x16x32_bf16 v[56:59], v[200:203], v[108:111], v[56:59]
    v_mfma_f32_16x16x32_bf16 v[60:63], v[204:207], v[108:111], v[60:63]
    s_waitcnt lgkmcnt(15)
    s_add_u32 m0, s81, 8192
    s_xor_b32 s27, s44, 0
    buffer_load_dwordx4 v4, s[48:51], s27 offen offset:0  lds
    v_mfma_f32_16x16x32_bf16 v[48:51], v[144:147], v[112:115], v[48:51]
    s_waitcnt lgkmcnt(0)
    s_barrier
    v_mfma_f32_16x16x32_bf16 v[52:55], v[148:151], v[112:115], v[52:55]
    ds_read_b128 v[80:83], v25 offset:24576
    ds_read_b128 v[84:87], v25 offset:25600
    v_mfma_f32_16x16x32_bf16 v[56:59], v[152:155], v[112:115], v[56:59]
    buffer_load_dwordx4 v5, s[48:51], s27 offen offset:1024  lds
    ds_read_b128 v[88:91], v27 offset:26624
    v_mfma_f32_16x16x32_bf16 v[60:63], v[156:159], v[112:115], v[60:63]
    ds_read_b128 v[92:95], v27 offset:27648
    v_mfma_f32_16x16x32_bf16 v[48:51], v[208:211], v[116:119], v[48:51]
    v_mfma_f32_16x16x32_bf16 v[52:55], v[212:215], v[116:119], v[52:55]
    buffer_load_dwordx4 v6, s[48:51], s27 offen offset:2048  lds
    v_mfma_f32_16x16x32_bf16 v[56:59], v[216:219], v[116:119], v[56:59]
    s_waitcnt lgkmcnt(0)
    v_add_f32 v80, v80, v88
    v_add_f32 v81, v81, v89
    v_mfma_f32_16x16x32_bf16 v[60:63], v[220:223], v[116:119], v[60:63]
    v_add_f32 v82, v82, v90
    v_add_f32 v83, v83, v91
    v_mfma_f32_16x16x32_bf16 v[48:51], v[224:227], v[120:123], v[48:51]
    v_add_f32 v84, v84, v92
    v_add_f32 v85, v85, v93
    v_mfma_f32_16x16x32_bf16 v[52:55], v[228:231], v[120:123], v[52:55]
    v_add_f32 v86, v86, v94
    v_add_f32 v87, v87, v95
    v_mfma_f32_16x16x32_bf16 v[56:59], v[232:235], v[120:123], v[56:59]
    s_waitcnt vmcnt(16)
    v_accvgpr_read_b32 v14, a192
    v_accvgpr_read_b32 v15, a196
    v_mfma_f32_16x16x32_bf16 v[60:63], v[236:239], v[120:123], v[60:63]
    v_accvgpr_read_b32 v13, a200
    v_max3_u32 v13, v14, v15, v13
    v_mfma_f32_16x16x32_bf16 v[48:51], v[240:243], v[124:127], v[48:51]
    v_accvgpr_read_b32 v14, a204
    v_max_u32 v13, v13, v14
    v_mfma_f32_16x16x32_bf16 v[52:55], v[244:247], v[124:127], v[52:55]
    v_cmp_eq_u32 vcc, -1, v13
    s_cbranch_vccnz ck_10s
ck_10r:
    v_mfma_f32_16x16x32_bf16 v[56:59], v[248:251], v[124:127], v[56:59]
    buffer_load_dwordx4 v7, s[48:51], s27 offen offset:3072  lds
    v_mfma_f32_16x16x32_bf16 v[60:63], v[252:255], v[124:127], v[60:63]
    v_mfma_f32_16x16x32_bf16 v[32:35], v[128:131], a[192:195], 0
    v_mfma_f32_16x16x32_bf16 v[36:39], v[132:135], a[192:195], 0
    ds_write2_b64 v70, v[50:51], v[54:55] offset0:0 offset1:1
    v_add_f32 v80, v80, v48
    v_mfma_f32_16x16x32_bf16 v[40:43], v[136:139], a[192:195], 0
    v_add_f32 v81, v81, v49
    v_add_f32 v82, v82, v52
    v_mfma_f32_16x16x32_bf16 v[44:47], v[140:143], a[192:195], 0
    v_add_f32 v83, v83, v53
    ds_write2_b64 v70, v[58:59], v[62:63] offset0:128 offset1:129
    v_mfma_f32_16x16x32_bf16 v[32:35], v[160:163], a[196:199], v[32:35]
    s_add_u32 m0, s81, 12288
    s_xor_b32 s27, s45, 0
    buffer_load_dwordx4 v4, s[48:51], s27 offen offset:0  lds
    v_add_f32 v84, v84, v56
    v_mfma_f32_16x16x32_bf16 v[36:39], v[164:167], a[196:199], v[36:39]
    v_add_f32 v85, v85, v57
    v_add_f32 v86, v86, v60
    v_mfma_f32_16x16x32_bf16 v[40:43], v[168:171], a[196:199], v[40:43]
    v_add_f32 v87, v87, v61
    v_mfma_f32_16x16x32_bf16 v[44:47], v[172:175], a[196:199], v[44:47]
    v_mfma_f32_16x16x32_bf16 v[32:35], v[176:179], a[200:203], v[32:35]
    s_waitcnt lgkmcnt(0)
    s_barrier
    v_mfma_f32_16x16x32_bf16 v[36:39], v[180:183], a[200:203], v[36:39]
    ds_read_b128 v[96:99], v26 offset:28672
    ds_read_b128 v[100:103], v26 offset:29696
    v_mfma_f32_16x16x32_bf16 v[40:43], v[184:187], a[200:203], v[40:43]
    s_waitcnt vmcnt(14)
    v_accvgpr_read_b32 v14, a144
    v_accvgpr_read_b32 v15, a148
    v_mfma_f32_16x16x32_bf16 v[44:47], v[188:191], a[200:203], v[44:47]
    v_accvgpr_read_b32 v13, a152
    v_max3_u32 v13, v14, v15, v13
    v_mfma_f32_16x16x32_bf16 v[32:35], v[192:195], a[204:207], v[32:35]
    v_accvgpr_read_b32 v14, a156
    v_max_u32 v13, v13, v14
    s_waitcnt lgkmcnt(0)
    v_mfma_f32_16x16x32_bf16 v[36:39], v[196:199], a[204:207], v[36:39]
    v_cmp_eq_u32 vcc, -1, v13
    s_cbranch_vccnz ck_11s
ck_11r:
    v_mfma_f32_16x16x32_bf16 v[40:43], v[200:203], a[204:207], v[40:43]
    buffer_load_dwordx4 v5, s[48:51], s27 offen offset:1024  lds
    v_add_f32 v96, v96, v80
    v_mfma_f32_16x16x32_bf16 v[44:47], v[204:207], a[204:207], v[44:47]
    v_add_f32 v97, v97, v81
    v_add_f32 v98, v98, v82
    v_mfma_f32_16x16x32_bf16 v[32:35], v[144:147], a[144:147], v[32:35]
    v_add_f32 v99, v99, v83
    v_add_f32 v100, v100, v84
    v_mfma_f32_16x16x32_bf16 v[36:39], v[148:151], a[144:147], v[36:39]
    v_add_f32 v101, v101, v85
    v_add_f32 v102, v102, v86
    v_mfma_f32_16x16x32_bf16 v[40:43], v[152:155], a[144:147], v[40:43]
    v_add_f32 v103, v103, v87
    v_cvt_pk_bf16_f32 v120, v96, v98
    v_mfma_f32_16x16x32_bf16 v[44:47], v[156:159], a[144:147], v[44:47]
    v_cvt_pk_bf16_f32 v121, v100, v102
    v_cvt_pk_bf16_f32 v122, v97, v99
    v_mfma_f32_16x16x32_bf16 v[32:35], v[208:211], a[148:151], v[32:35]
    v_cvt_pk_bf16_f32 v123, v101, v103
    v_min_u32 v120, -2, v120
    v_mfma_f32_16x16x32_bf16 v[36:39], v[212:215], a[148:151], v[36:39]
    buffer_store_dwordx4 v[120:123], v1, s[56:59], s36 offen sc1
    v_mfma_f32_16x16x32_bf16 v[40:43], v[216:219], a[148:151], v[40:43]
    v_mfma_f32_16x16x32_bf16 v[44:47], v[220:223], a[148:151], v[44:47]
    v_mfma_f32_16x16x32_bf16 v[32:35], v[224:227], a[152:155], v[32:35]
    buffer_load_dwordx4 v6, s[48:51], s27 offen offset:2048  lds
    v_mfma_f32_16x16x32_bf16 v[36:39], v[228:231], a[152:155], v[36:39]
    v_mfma_f32_16x16x32_bf16 v[40:43], v[232:235], a[152:155], v[40:43]
    s_waitcnt vmcnt(13)
    v_accvgpr_read_b32 v14, a176
    v_accvgpr_read_b32 v15, a180
    v_mfma_f32_16x16x32_bf16 v[44:47], v[236:239], a[152:155], v[44:47]
    v_accvgpr_read_b32 v13, a184
    v_max3_u32 v13, v14, v15, v13
    v_mfma_f32_16x16x32_bf16 v[32:35], v[240:243], a[156:159], v[32:35]
    v_accvgpr_read_b32 v14, a188
    v_max_u32 v13, v13, v14
    v_mfma_f32_16x16x32_bf16 v[36:39], v[244:247], a[156:159], v[36:39]
    v_cmp_eq_u32 vcc, -1, v13
    s_cbranch_vccnz ck_12s
ck_12r:
    v_mfma_f32_16x16x32_bf16 v[40:43], v[248:251], a[156:159], v[40:43]
    buffer_load_dwordx4 v7, s[48:51], s27 offen offset:3072  lds
    v_mfma_f32_16x16x32_bf16 v[44:47], v[252:255], a[156:159], v[44:47]
    v_mfma_f32_16x16x32_bf16 v[80:83], v[128:131], a[176:179], 0
    ds_write2_b64 v71, v[32:33], v[36:37] offset0:0 offset1:1
    v_mfma_f32_16x16x32_bf16 v[84:87], v[132:135], a[176:179], 0
    s_add_u32 m0, s81, 16384
    s_xor_b32 s27, s46, 0
    buffer_load_dwordx4 v4, s[48:51], s27 offen offset:0  lds
    v_mfma_f32_16x16x32_bf16 v[88:91], v[136:139], a[176:179], 0
    v_mfma_f32_16x16x32_bf16 v[92:95], v[140:143], a[176:179], 0
    ds_write2_b64 v71, v[40:41], v[44:45] offset0:128 offset1:129
    v_mfma_f32_16x16x32_bf16 v[80:83], v[160:163], a[180:183], v[80:83]
    buffer_load_dwordx4 v5, s[48:51], s27 offen offset:1024  lds
    v_mfma_f32_16x16x32_bf16 v[84:87], v[164:167], a[180:183], v[84:87]
    v_mfma_f32_16x16x32_bf16 v[88:91], v[168:171], a[180:183], v[88:91]
    ds_write2_b64 v72, v[34:35], v[38:39] offset0:0 offset1:1
    v_mfma_f32_16x16x32_bf16 v[92:95], v[172:175], a[180:183], v[92:95]
    buffer_load_dwordx4 v6, s[48:51], s27 offen offset:2048  lds
    v_mfma_f32_16x16x32_bf16 v[80:83], v[176:179], a[184:187], v[80:83]
    v_mfma_f32_16x16x32_bf16 v[84:87], v[180:183], a[184:187], v[84:87]
    ds_write2_b64 v72, v[42:43], v[46:47] offset0:128 offset1:129
    v_mfma_f32_16x16x32_bf16 v[88:91], v[184:187], a[184:187], v[88:91]
    s_waitcnt vmcnt(13)
    v_accvgpr_read_b32 v14, a208
    v_accvgpr_read_b32 v15, a212
    v_mfma_f32_16x16x32_bf16 v[92:95], v[188:191], a[184:187], v[92:95]
    v_accvgpr_read_b32 v13, a216
    v_max3_u32 v13, v14, v15, v13
    v_mfma_f32_16x16x32_bf16 v[80:83], v[192:195], a[188:191], v[80:83]
    v_accvgpr_read_b32 v14, a220
    v_max_u32 v13, v13, v14
    v_mfma_f32_16x16x32_bf16 v[84:87], v[196:199], a[188:191], v[84:87]
    v_cmp_eq_u32 vcc, -1, v13
    s_cbranch_vccnz ck_13s
ck_13r:
    v_mfma_f32_16x16x32_bf16 v[88:91], v[200:203], a[188:191], v[88:91]
    buffer_load_dwordx4 v7, s[48:51], s27 offen offset:3072  lds
    v_mfma_f32_16x16x32_bf16 v[92:95], v[204:207], a[188:191], v[92:95]
    s_waitcnt lgkmcnt(0)
    s_barrier
    v_mfma_f32_16x16x32_bf16 v[80:83], v[144:147], a[208:211], v[80:83]
    ds_read_b128 v[96:99], v25 offset:30720
    ds_read_b128 v[100:103], v25 offset:31744
    v_mfma_f32_16x16x32_bf16 v[84:87], v[148:151], a[208:211], v[84:87]
    ds_read_b128 v[104:107], v27 offset:32768
    ds_read_b128 v[108:111], v27 offset:33792
    v_mfma_f32_16x16x32_bf16 v[88:91], v[152:155], a[208:211], v[88:91]
    v_mfma_f32_16x16x32_bf16 v[92:95], v[156:159], a[208:211], v[92:95]
    v_mfma_f32_16x16x32_bf16 v[80:83], v[208:211], a[212:215], v[80:83]
    s_waitcnt lgkmcnt(0)
    v_add_f32 v96, v96, v104
    v_add_f32 v97, v97, v105
    v_mfma_f32_16x16x32_bf16 v[84:87], v[212:215], a[212:215], v[84:87]
    v_add_f32 v98, v98, v106
    v_add_f32 v99, v99, v107
    v_mfma_f32_16x16x32_bf16 v[88:91], v[216:219], a[212:215], v[88:91]
    v_add_f32 v100, v100, v108
    v_add_f32 v101, v101, v109
    v_mfma_f32_16x16x32_bf16 v[92:95], v[220:223], a[212:215], v[92:95]
    v_add_f32 v102, v102, v110
    v_add_f32 v103, v103, v111
    v_mfma_f32_16x16x32_bf16 v[80:83], v[224:227], a[216:219], v[80:83]
    v_mfma_f32_16x16x32_bf16 v[84:87], v[228:231], a[216:219], v[84:87]
    v_mfma_f32_16x16x32_bf16 v[88:91], v[232:235], a[216:219], v[88:91]
    v_mfma_f32_16x16x32_bf16 v[92:95], v[236:239], a[216:219], v[92:95]
    v_mfma_f32_16x16x32_bf16 v[80:83], v[240:243], a[220:223], v[80:83]
    v_mfma_f32_16x16x32_bf16 v[84:87], v[244:247], a[220:223], v[84:87]
    v_mfma_f32_16x16x32_bf16 v[88:91], v[248:251], a[220:223], v[88:91]
    v_mfma_f32_16x16x32_bf16 v[92:95], v[252:255], a[220:223], v[92:95]
    s_nop 7
    ds_write2_b64 v73, v[82:83], v[86:87] offset0:0 offset1:1
    ds_write2_b64 v73, v[90:91], v[94:95] offset0:128 offset1:129
    v_pk_add_f32 v[96:97], v[96:97], v[80:81]
    v_pk_add_f32 v[98:99], v[98:99], v[84:85]
    v_pk_add_f32 v[100:101], v[100:101], v[88:89]
    v_pk_add_f32 v[102:103], v[102:103], v[92:93]
    s_add_u32 m0, s81, 20480
    s_xor_b32 s27, s44, 128
    buffer_load_dwordx4 v4, s[48:51], s27 offen offset:0  lds
    buffer_load_dwordx4 v5, s[48:51], s27 offen offset:1024  lds
    buffer_load_dwordx4 v6, s[48:51], s27 offen offset:2048  lds
    buffer_load_dwordx4 v7, s[48:51], s27 offen offset:3072  lds
    s_waitcnt lgkmcnt(0)
    s_barrier
    ds_read_b128 v[104:107], v26 offset:34816
    ds_read_b128 v[108:111], v26 offset:35840
    s_waitcnt lgkmcnt(0)
    v_pk_add_f32 v[96:97], v[96:97], v[104:105]
    v_pk_add_f32 v[98:99], v[98:99], v[106:107]
    v_pk_add_f32 v[100:101], v[100:101], v[108:109]
    v_pk_add_f32 v[102:103], v[102:103], v[110:111]
    v_cvt_pk_bf16_f32 v120, v96, v98
    v_cvt_pk_bf16_f32 v121, v100, v102
    v_cvt_pk_bf16_f32 v122, v97, v99
    v_cvt_pk_bf16_f32 v123, v101, v103
    v_min_u32 v120, -2, v120
    s_waitcnt vmcnt(13)
    ds_read_b64_tr_b16 a[128:129], v8 offset:8192
    ds_read_b64_tr_b16 a[130:131], v8 offset:10240
    ds_read_b64_tr_b16 a[132:133], v9 offset:8192
    ds_read_b64_tr_b16 a[134:135], v9 offset:10240
    ds_read_b64_tr_b16 a[136:137], v10 offset:8192
    ds_read_b64_tr_b16 a[138:139], v10 offset:10240
    ds_read_b64_tr_b16 a[140:141], v11 offset:8192
    ds_read_b64_tr_b16 a[142:143], v11 offset:10240
    s_add_u32 m0, s81, 0
    s_xor_b32 s27, s45, 128
    buffer_load_dwordx4 v4, s[48:51], s27 offen offset:0  lds
    buffer_load_dwordx4 v5, s[48:51], s27 offen offset:1024  lds
    buffer_load_dwordx4 v6, s[48:51], s27 offen offset:2048  lds
    buffer_load_dwordx4 v7, s[48:51], s27 offen offset:3072  lds
    s_waitcnt vmcnt(12)
    ds_read_b64_tr_b16 a[160:161], v8 offset:12288
    ds_read_b64_tr_b16 a[162:163], v8 offset:14336
    ds_read_b64_tr_b16 a[164:165], v9 offset:12288
    ds_read_b64_tr_b16 a[166:167], v9 offset:14336
    ds_read_b64_tr_b16 a[168:169], v10 offset:12288
    ds_read_b64_tr_b16 a[170:171], v10 offset:14336
    ds_read_b64_tr_b16 a[172:173], v11 offset:12288
    ds_read_b64_tr_b16 a[174:175], v11 offset:14336
    s_mov_b32 exec_hi, 0
    s_mov_b32 s85, 30000
pl_14:
    v_cmp_ne_u64 vcc, s[72:73], v[30:31]
    s_cbranch_vccz po_15
    s_sub_u32 s85, s85, 1
    s_cbranch_scc1 po_15
    buffer_load_dwordx2 v[30:31], v0, s[56:59], s70 offen sc1
    s_waitcnt vmcnt(0)
    s_branch pl_14
po_15:
    s_mov_b64 exec, -1
    buffer_load_dword v2, v29, s[56:59], 0 offen sc1
    buffer_load_dwordx4 v[180:183], v17, s[56:59], s74 offen sc1
    buffer_load_dwordx4 v[188:191], v17, s[56:59], s75 offen sc1
    buffer_load_dwordx4 v[196:199], v17, s[56:59], s76 offen sc1
    buffer_load_dwordx4 v[204:207], v17, s[56:59], s77 offen sc1
    buffer_load_dwordx4 v[212:215], v17, s[56:59], s78 offen sc1
    buffer_load_dwordx4 v[220:223], v17, s[56:59], s79 offen sc1
    buffer_load_dwordx4 v[228:231], v17, s[56:59], s80 offen sc1
    buffer_store_dwordx4 v[120:123], v1, s[56:59], s37 offen sc1
    s_lshl2_add_u32 s36, s4, s3
    s_mul_i32 s36, s36, 12
    s_add_u32 s36, s36, s68
    s_mul_i32 s36, s36, 4352
    s_add_u32 s36, s36, 4194304
    s_add_u32 s37, s36, 17408
    s_add_u32 s38, s36, 34816
    s_and_b32 s82, s4, 1
    s_lshl2_add_u32 s82, s82, s3
    s_lshr_b32 s83, s68, 1
    s_lshl1_add_u32 s82, s82, s83
    s_mul_i32 s82, s82, 114688
    s_lshr_b32 s83, s4, 1
    s_lshl_b32 s83, s83, 8
    s_add_u32 s82, s82, s83
    s_add_u32 s31, s82, s5
    s_xor_b32 s39, s3, 2
    s_and_b32 s39, s39, 3
    s_lshl2_add_u32 s39, s4, s39
    s_mul_i32 s39, s39, 12
    s_add_u32 s39, s39, s68
    s_mul_i32 s39, s39, 4352
    s_add_u32 s39, s39, 4194304
    s_xor_b32 s40, s3, 1
    s_and_b32 s40, s40, 3
    s_lshl2_add_u32 s40, s4, s40
    s_mul_i32 s40, s40, 12
    s_add_u32 s40, s40, s68
    s_mul_i32 s40, s40, 4352
    s_add_u32 s40, s40, 4211712
    s_xor_b32 s41, s3, 3
    s_and_b32 s41, s41, 3
    s_lshl2_add_u32 s41, s4, s41
    s_mul_i32 s41, s41, 12
    s_add_u32 s41, s41, s68
    s_mul_i32 s41, s41, 4352
    s_add_u32 s41, s41, 4229120
    v_lshrrev_b32 v12, 1, v0
    v_add_u32 v12, 4096, v12
    s_waitcnt vmcnt(17)
    ds_read_b64_tr_b16 a[192:193], v8 offset:16384
    ds_read_b64_tr_b16 a[194:195], v8 offset:18432
    ds_read_b64_tr_b16 a[196:197], v9 offset:16384
    ds_read_b64_tr_b16 a[198:199], v9 offset:18432
    ds_read_b64_tr_b16 a[200:201], v10 offset:16384
    ds_read_b64_tr_b16 a[202:203], v10 offset:18432
    ds_read_b64_tr_b16 a[204:205], v11 offset:16384
    ds_read_b64_tr_b16 a[206:207], v11 offset:18432
    s_waitcnt vmcnt(13)
    ds_read_b64_tr_b16 a[144:145], v8 offset:20480
    ds_read_b64_tr_b16 a[146:147], v8 offset:22528
    ds_read_b64_tr_b16 a[148:149], v9 offset:20480
    ds_read_b64_tr_b16 a[150:151], v9 offset:22528
    ds_read_b64_tr_b16 a[152:153], v10 offset:20480
    ds_read_b64_tr_b16 a[154:155], v10 offset:22528
    ds_read_b64_tr_b16 a[156:157], v11 offset:20480
    ds_read_b64_tr_b16 a[158:159], v11 offset:22528
    s_waitcnt vmcnt(9)
    ds_read_b64_tr_b16 a[176:177], v8 offset:0
    ds_read_b64_tr_b16 a[178:179], v8 offset:2048
    ds_read_b64_tr_b16 a[180:181], v9 offset:0
    ds_read_b64_tr_b16 a[182:183], v9 offset:2048
    ds_read_b64_tr_b16 a[184:185], v10 offset:0
    ds_read_b64_tr_b16 a[186:187], v10 offset:2048
    ds_read_b64_tr_b16 a[188:189], v11 offset:0
    ds_read_b64_tr_b16 a[190:191], v11 offset:2048
    s_waitcnt vmcnt(8)
    v_cmp_eq_u32 vcc, -1, v2
    s_cbranch_vccnz gt_16s
gt_16o:
    s_add_u32 m0, s81, 4096
    s_xor_b32 s27, s46, 128
    buffer_load_dwordx4 v4, s[48:51], s27 offen offset:0  lds
    buffer_load_dwordx4 v5, s[48:51], s27 offen offset:1024  lds
    buffer_load_dwordx4 v6, s[48:51], s27 offen offset:2048  lds
    buffer_load_dwordx4 v7, s[48:51], s27 offen offset:3072  lds
    s_waitcnt vmcnt(10)
    v_max_u32 v13, v180, v188
    v_cmp_eq_u32 vcc, -1, v13
    s_cbranch_vccnz ck_17s
ck_17r:
    v_mfma_f32_16x16x32_bf16 v[32:35], a[0:3], v[180:183], 0
    s_waitcnt vmcnt(8)
    v_max_u32 v13, v196, v204
    v_cmp_eq_u32 vcc, -1, v13
    v_mfma_f32_16x16x32_bf16 v[36:39], a[4:7], v[180:183], 0
    s_cbranch_vccnz ck_18s
ck_18r:
    v_mfma_f32_16x16x32_bf16 v[40:43], a[8:11], v[180:183], 0
    v_mfma_f32_16x16x32_bf16 v[44:47], a[12:15], v[180:183], 0
    v_mfma_f32_16x16x32_bf16 v[32:35], a[32:35], v[188:191], v[32:35]
    buffer_load_dwordx4 v[176:179], v16, s[56:59], s74 offen sc1
    v_mfma_f32_16x16x32_bf16 v[36:39], a[36:39], v[188:191], v[36:39]
    v_mfma_f32_16x16x32_bf16 v[40:43], a[40:43], v[188:191], v[40:43]
    v_mfma_f32_16x16x32_bf16 v[44:47], a[44:47], v[188:191], v[44:47]
    v_mfma_f32_16x16x32_bf16 v[32:35], a[64:67], v[196:199], v[32:35]
    s_waitcnt vmcnt(6)
    v_max3_u32 v13, v212, v220, v228
    v_cmp_eq_u32 vcc, -1, v13
    v_mfma_f32_16x16x32_bf16 v[36:39], a[68:71], v[196:199], v[36:39]
    s_cbranch_vccnz ck_19s
ck_19r:
    buffer_load_dwordx4 v[184:187], v16, s[56:59], s75 offen sc1
    v_mfma_f32_16x16x32_bf16 v[40:43], a[72:75], v[196:199], v[40:43]
    v_mfma_f32_16x16x32_bf16 v[44:47], a[76:79], v[196:199], v[44:47]
    v_mfma_f32_16x16x32_bf16 v[32:35], a[96:99], v[204:207], v[32:35]
    v_mfma_f32_16x16x32_bf16 v[36:39], a[100:103], v[204:207], v[36:39]
    buffer_load_dwordx4 v[192:195], v16, s[56:59], s76 offen sc1
    v_mfma_f32_16x16x32_bf16 v[40:43], a[104:107], v[204:207], v[40:43]
    v_mfma_f32_16x16x32_bf16 v[44:47], a[108:111], v[204:207], v[44:47]
    s_waitcnt lgkmcnt(15)
    v_mfma_f32_16x16x32_bf16 v[32:35], a[128:131], v[212:215], v[32:35]
    v_mfma_f32_16x16x32_bf16 v[36:39], a[132:135], v[212:215], v[36:39]
    buffer_load_dwordx4 v[200:203], v16, s[56:59], s77 offen sc1
    v_mfma_f32_16x16x32_bf16 v[40:43], a[136:139], v[212:215], v[40:43]
    v_mfma_f32_16x16x32_bf16 v[44:47], a[140:143], v[212:215], v[44:47]
    v_mfma_f32_16x16x32_bf16 v[32:35], a[160:163], v[220:223], v[32:35]
    v_mfma_f32_16x16x32_bf16 v[36:39], a[164:167], v[220:223], v[36:39]
    buffer_load_dwordx4 v[208:211], v16, s[56:59], s78 offen sc1
    v_mfma_f32_16x16x32_bf16 v[40:43], a[168:171], v[220:223], v[40:43]
    v_mfma_f32_16x16x32_bf16 v[44:47], a[172:175], v[220:223], v[44:47]
    v_mfma_f32_16x16x32_bf16 v[32:35], a[192:195], v[228:231], v[32:35]
    v_mfma_f32_16x16x32_bf16 v[36:39], a[196:199], v[228:231], v[36:39]
    buffer_load_dwordx4 v[216:219], v16, s[56:59], s79 offen sc1
    v_mfma_f32_16x16x32_bf16 v[40:43], a[200:203], v[228:231], v[40:43]
    v_mfma_f32_16x16x32_bf16 v[44:47], a[204:207], v[228:231], v[44:47]
    v_mfma_f32_16x16x32_bf16 v[48:51], a[16:19], v[180:183], 0
    ds_write_b128 v24, v[32:35] offset:36864
    v_mfma_f32_16x16x32_bf16 v[52:55], a[20:23], v[180:183], 0
    buffer_load_dwordx4 v[224:227], v16, s[56:59], s80 offen sc1
    v_mfma_f32_16x16x32_bf16 v[56:59], a[24:27], v[180:183], 0
    v_mfma_f32_16x16x32_bf16 v[60:63], a[28:31], v[180:183], 0
    v_mfma_f32_16x16x32_bf16 v[48:51], a[48:51], v[188:191], v[48:51]
    ds_write_b128 v24, v[36:39] offset:37888
    v_mfma_f32_16x16x32_bf16 v[52:55], a[52:55], v[188:191], v[52:55]
    v_mfma_f32_16x16x32_bf16 v[56:59], a[56:59], v[188:191], v[56:59]
    v_mfma_f32_16x16x32_bf16 v[60:63], a[60:63], v[188:191], v[60:63]
    v_mfma_f32_16x16x32_bf16 v[48:51], a[80:83], v[196:199], v[48:51]
    ds_write_b128 v24, v[40:43] offset:38912
    v_mfma_f32_16x16x32_bf16 v[52:55], a[84:87], v[196:199], v[52:55]
    v_mfma_f32_16x16x32_bf16 v[56:59], a[88:91], v[196:199], v[56:59]
    v_mfma_f32_16x16x32_bf16 v[60:63], a[92:95], v[196:199], v[60:63]
    v_mfma_f32_16x16x32_bf16 v[48:51], a[112:115], v[204:207], v[48:51]
    buffer_load_dwordx4 v[236:239], v19, s[56:59], s74 offen sc1
    ds_write_b128 v24, v[44:47] offset:39936
    v_mfma_f32_16x16x32_bf16 v[52:55], a[116:119], v[204:207], v[52:55]
    s_waitcnt vmcnt(8)
    ds_read_b64_tr_b16 a[208:209], v8 offset:4096
    ds_read_b64_tr_b16 a[210:211], v8 offset:6144
    ds_read_b64_tr_b16 a[212:213], v9 offset:4096
    ds_read_b64_tr_b16 a[214:215], v9 offset:6144
    ds_read_b64_tr_b16 a[216:217], v10 offset:4096
    ds_read_b64_tr_b16 a[218:219], v10 offset:6144
    ds_read_b64_tr_b16 a[220:221], v11 offset:4096
    ds_read_b64_tr_b16 a[222:223], v11 offset:6144
    v_mfma_f32_16x16x32_bf16 v[56:59], a[120:123], v[204:207], v[56:59]
    v_mfma_f32_16x16x32_bf16 v[60:63], a[124:127], v[204:207], v[60:63]
    s_waitcnt lgkmcnt(0)
    s_barrier
    v_mfma_f32_16x16x32_bf16 v[48:51], a[144:147], v[212:215], v[48:51]
    buffer_load_dwordx4 v[244:247], v19, s[56:59], s75 offen sc1
    ds_read_b128 v[32:35], v27 offset:36864
    v_mfma_f32_16x16x32_bf16 v[52:55], a[148:151], v[212:215], v[52:55]
    ds_read_b128 v[36:39], v27 offset:37888
    v_mfma_f32_16x16x32_bf16 v[56:59], a[152:155], v[212:215], v[56:59]
    ds_read_b128 v[40:43], v27 offset:38912
    v_mfma_f32_16x16x32_bf16 v[60:63], a[156:159], v[212:215], v[60:63]
    ds_read_b128 v[44:47], v27 offset:39936
    v_mfma_f32_16x16x32_bf16 v[48:51], a[176:179], v[220:223], v[48:51]
    s_waitcnt vmcnt(5)
    v_max3_u32 v13, v176, v184, v192
    v_max_u32 v13, v13, v200
    v_mfma_f32_16x16x32_bf16 v[52:55], a[180:183], v[220:223], v[52:55]
    v_cmp_eq_u32 vcc, -1, v13
    s_cbranch_vccnz ck_20s
ck_20r:
    v_mfma_f32_16x16x32_bf16 v[56:59], a[184:187], v[220:223], v[56:59]
    buffer_load_dwordx4 v[252:255], v19, s[56:59], s76 offen sc1
    v_mfma_f32_16x16x32_bf16 v[60:63], a[188:191], v[220:223], v[60:63]
    v_mfma_f32_16x16x32_bf16 v[48:51], a[208:211], v[228:231], v[48:51]
    v_mfma_f32_16x16x32_bf16 v[52:55], a[212:215], v[228:231], v[52:55]
    v_mfma_f32_16x16x32_bf16 v[56:59], a[216:219], v[228:231], v[56:59]
    buffer_load_dwordx4 a[228:231], v19, s[56:59], s77 offen sc1
    v_mfma_f32_16x16x32_bf16 v[60:63], a[220:223], v[228:231], v[60:63]
    s_waitcnt lgkmcnt(0)
    v_mfma_f32_16x16x32_bf16 v[32:35], a[16:19], v[176:179], v[32:35]
    ds_write_b128 v24, v[48:51] offset:24576
    v_mfma_f32_16x16x32_bf16 v[36:39], a[20:23], v[176:179], v[36:39]
    v_mfma_f32_16x16x32_bf16 v[40:43], a[24:27], v[176:179], v[40:43]
    buffer_load_dwordx4 a[236:239], v19, s[56:59], s78 offen sc1
    v_mfma_f32_16x16x32_bf16 v[44:47], a[28:31], v[176:179], v[44:47]
    v_mfma_f32_16x16x32_bf16 v[32:35], a[48:51], v[184:187], v[32:35]
    ds_write_b128 v24, v[52:55] offset:25600
    v_mfma_f32_16x16x32_bf16 v[36:39], a[52:55], v[184:187], v[36:39]
    v_mfma_f32_16x16x32_bf16 v[40:43], a[56:59], v[184:187], v[40:43]
    buffer_load_dwordx4 a[244:247], v19, s[56:59], s79 offen sc1
    v_mfma_f32_16x16x32_bf16 v[44:47], a[60:63], v[184:187], v[44:47]
    v_mfma_f32_16x16x32_bf16 v[32:35], a[80:83], v[192:195], v[32:35]
    s_waitcnt vmcnt(6)
    v_max3_u32 v13, v208, v216, v224
    v_cmp_eq_u32 vcc, -1, v13
    v_mfma_f32_16x16x32_bf16 v[36:39], a[84:87], v[192:195], v[36:39]
    s_cbranch_vccnz ck_21s
ck_21r:
    ds_write_b128 v24, v[56:59] offset:26624
    v_mfma_f32_16x16x32_bf16 v[40:43], a[88:91], v[192:195], v[40:43]
    buffer_load_dwordx4 a[252:255], v19, s[56:59], s80 offen sc1
    v_mfma_f32_16x16x32_bf16 v[44:47], a[92:95], v[192:195], v[44:47]
    v_mfma_f32_16x16x32_bf16 v[32:35], a[112:115], v[200:203], v[32:35]
    v_mfma_f32_16x16x32_bf16 v[36:39], a[116:119], v[200:203], v[36:39]
    ds_write_b128 v24, v[60:63] offset:27648
    v_mfma_f32_16x16x32_bf16 v[40:43], a[120:123], v[200:203], v[40:43]
    buffer_load_dwordx4 v[232:235], v18, s[56:59], s74 offen sc1
    v_mfma_f32_16x16x32_bf16 v[44:47], a[124:127], v[200:203], v[44:47]
    v_mfma_f32_16x16x32_bf16 v[32:35], a[144:147], v[208:211], v[32:35]
    s_waitcnt lgkmcnt(0)
    s_barrier
    v_mfma_f32_16x16x32_bf16 v[36:39], a[148:151], v[208:211], v[36:39]
    ds_read_b128 v[48:51], v27 offset:24576
    v_mfma_f32_16x16x32_bf16 v[40:43], a[152:155], v[208:211], v[40:43]
    buffer_load_dwordx4 v[240:243], v18, s[56:59], s75 offen sc1
    ds_read_b128 v[52:55], v27 offset:25600
    v_mfma_f32_16x16x32_bf16 v[44:47], a[156:159], v[208:211], v[44:47]
    ds_read_b128 v[56:59], v27 offset:26624
    v_mfma_f32_16x16x32_bf16 v[32:35], a[176:179], v[216:219], v[32:35]
    ds_read_b128 v[60:63], v27 offset:27648
    v_mfma_f32_16x16x32_bf16 v[36:39], a[180:183], v[216:219], v[36:39]
    v_mfma_f32_16x16x32_bf16 v[40:43], a[184:187], v[216:219], v[40:43]
    buffer_load_dwordx4 v[248:251], v18, s[56:59], s76 offen sc1
    v_mfma_f32_16x16x32_bf16 v[44:47], a[188:191], v[216:219], v[44:47]
    v_mfma_f32_16x16x32_bf16 v[32:35], a[208:211], v[224:227], v[32:35]
    v_mfma_f32_16x16x32_bf16 v[36:39], a[212:215], v[224:227], v[36:39]
    v_mfma_f32_16x16x32_bf16 v[40:43], a[216:219], v[224:227], v[40:43]
    buffer_load_dwordx4 a[224:227], v18, s[56:59], s77 offen sc1
    v_mfma_f32_16x16x32_bf16 v[44:47], a[220:223], v[224:227], v[44:47]
    s_waitcnt lgkmcnt(0)
    v_mfma_f32_16x16x32_bf16 v[48:51], a[0:3], v[176:179], v[48:51]
    ds_write_b128 v24, v[32:35] offset:28672
    v_mfma_f32_16x16x32_bf16 v[52:55], a[4:7], v[176:179], v[52:55]
    v_mfma_f32_16x16x32_bf16 v[56:59], a[8:11], v[176:179], v[56:59]
    buffer_load_dwordx4 a[232:235], v18, s[56:59], s78 offen sc1
    v_mfma_f32_16x16x32_bf16 v[60:63], a[12:15], v[176:179], v[60:63]
    v_mfma_f32_16x16x32_bf16 v[48:51], a[32:35], v[184:187], v[48:51]
    ds_write_b128 v24, v[36:39] offset:29696
    v_mfma_f32_16x16x32_bf16 v[52:55], a[36:39], v[184:187], v[52:55]
    v_mfma_f32_16x16x32_bf16 v[56:59], a[40:43], v[184:187], v[56:59]
    buffer_load_dwordx4 a[240:243], v18, s[56:59], s79 offen sc1
    v_mfma_f32_16x16x32_bf16 v[60:63], a[44:47], v[184:187], v[60:63]
    v_mfma_f32_16x16x32_bf16 v[48:51], a[64:67], v[192:195], v[48:51]
    ds_write_b128 v24, v[40:43] offset:30720
    v_mfma_f32_16x16x32_bf16 v[52:55], a[68:71], v[192:195], v[52:55]
    v_mfma_f32_16x16x32_bf16 v[56:59], a[72:75], v[192:195], v[56:59]
    buffer_load_dwordx4 a[248:251], v18, s[56:59], s80 offen sc1
    v_mfma_f32_16x16x32_bf16 v[60:63], a[76:79], v[192:195], v[60:63]
    v_mfma_f32_16x16x32_bf16 v[48:51], a[96:99], v[200:203], v[48:51]
    ds_write_b128 v24, v[44:47] offset:31744
    v_mfma_f32_16x16x32_bf16 v[52:55], a[100:103], v[200:203], v[52:55]
    v_mfma_f32_16x16x32_bf16 v[56:59], a[104:107], v[200:203], v[56:59]
    buffer_load_dwordx4 v[180:183], v21, s[56:59], s74 offen sc1
    v_mfma_f32_16x16x32_bf16 v[60:63], a[108:111], v[200:203], v[60:63]
    s_waitcnt lgkmcnt(0)
    s_barrier
    v_mfma_f32_16x16x32_bf16 v[48:51], a[128:131], v[208:211], v[48:51]
    ds_read_b128 v[32:35], v25 offset:28672
    v_mfma_f32_16x16x32_bf16 v[52:55], a[132:135], v[208:211], v[52:55]
    ds_read_b128 v[36:39], v25 offset:29696
    v_mfma_f32_16x16x32_bf16 v[56:59], a[136:139], v[208:211], v[56:59]
    buffer_load_dwordx4 v[188:191], v21, s[56:59], s75 offen sc1
    ds_read_b128 v[40:43], v25 offset:30720
    v_mfma_f32_16x16x32_bf16 v[60:63], a[140:143], v[208:211], v[60:63]
    ds_read_b128 v[44:47], v25 offset:31744
    v_mfma_f32_16x16x32_bf16 v[48:51], a[160:163], v[216:219], v[48:51]
    s_waitcnt vmcnt(12)
    v_max3_u32 v13, v236, v244, v252
    v_accvgpr_read_b32 v14, a228
    v_mfma_f32_16x16x32_bf16 v[52:55], a[164:167], v[216:219], v[52:55]
    v_max_u32 v13, v13, v14
    v_cmp_eq_u32 vcc, -1, v13
    v_mfma_f32_16x16x32_bf16 v[56:59], a[168:171], v[216:219], v[56:59]
    s_cbranch_vccnz ck_22s
ck_22r:
    buffer_load_dwordx4 v[196:199], v21, s[56:59], s76 offen sc1
    v_mfma_f32_16x16x32_bf16 v[60:63], a[172:175], v[216:219], v[60:63]
    v_mfma_f32_16x16x32_bf16 v[48:51], a[192:195], v[224:227], v[48:51]
    v_mfma_f32_16x16x32_bf16 v[52:55], a[196:199], v[224:227], v[52:55]
    v_mfma_f32_16x16x32_bf16 v[56:59], a[200:203], v[224:227], v[56:59]
    buffer_load_dwordx4 v[204:207], v21, s[56:59], s77 offen sc1
    v_mfma_f32_16x16x32_bf16 v[60:63], a[204:207], v[224:227], v[60:63]
    v_mfma_f32_16x16x32_bf16 v[64:67], a[0:3], v[236:239], 0
    s_waitcnt lgkmcnt(0)
    v_add_f32 v96, v48, v32
    v_mfma_f32_16x16x32_bf16 v[68:71], a[4:7], v[236:239], 0
    v_add_f32 v97, v49, v33
    v_add_f32 v98, v50, v34
    v_mfma_f32_16x16x32_bf16 v[72:75], a[8:11], v[236:239], 0
    v_add_f32 v99, v51, v35
    buffer_store_dwordx4 v[96:99], v1, s[56:59], s39 offen offset:0 sc1
    v_mfma_f32_16x16x32_bf16 v[76:79], a[12:15], v[236:239], 0
    v_add3_u32 v112, v96, v97, s72
    v_add3_u32 v112, v98, v99, v112
    v_mfma_f32_16x16x32_bf16 v[64:67], a[32:35], v[244:247], v[64:67]
    v_add_f32 v100, v52, v36
    v_add_f32 v101, v53, v37
    v_mfma_f32_16x16x32_bf16 v[68:71], a[36:39], v[244:247], v[68:71]
    v_add_f32 v102, v54, v38
    v_add_f32 v103, v55, v39
    v_mfma_f32_16x16x32_bf16 v[72:75], a[40:43], v[244:247], v[72:75]
    buffer_store_dwordx4 v[100:103], v1, s[56:59], s39 offen offset:1024 sc1
    v_add3_u32 v112, v100, v101, v112
    v_mfma_f32_16x16x32_bf16 v[76:79], a[44:47], v[244:247], v[76:79]
    v_add3_u32 v112, v102, v103, v112
    v_add_f32 v104, v56, v40
    v_mfma_f32_16x16x32_bf16 v[64:67], a[64:67], v[252:255], v[64:67]
    s_waitcnt vmcnt(13)
    v_accvgpr_read_b32 v14, a236
    v_accvgpr_read_b32 v15, a244
    v_mfma_f32_16x16x32_bf16 v[68:71], a[68:71], v[252:255], v[68:71]
    v_accvgpr_read_b32 v13, a252
    v_max3_u32 v13, v14, v15, v13
    v_mfma_f32_16x16x32_bf16 v[72:75], a[72:75], v[252:255], v[72:75]
    v_cmp_eq_u32 vcc, -1, v13
    s_cbranch_vccnz ck_23s
ck_23r:
    v_mfma_f32_16x16x32_bf16 v[76:79], a[76:79], v[252:255], v[76:79]
    v_add_f32 v105, v57, v41
    v_add_f32 v106, v58, v42
    v_mfma_f32_16x16x32_bf16 v[64:67], a[96:99], a[228:231], v[64:67]
    v_add_f32 v107, v59, v43
    buffer_store_dwordx4 v[104:107], v1, s[56:59], s39 offen offset:2048 sc1
    v_mfma_f32_16x16x32_bf16 v[68:71], a[100:103], a[228:231], v[68:71]
    v_add3_u32 v112, v104, v105, v112
    v_add3_u32 v112, v106, v107, v112
    v_mfma_f32_16x16x32_bf16 v[72:75], a[104:107], a[228:231], v[72:75]
    v_add_f32 v108, v60, v44
    v_add_f32 v109, v61, v45
    v_mfma_f32_16x16x32_bf16 v[76:79], a[108:111], a[228:231], v[76:79]
    v_add_f32 v110, v62, v46
    v_add_f32 v111, v63, v47
    v_mfma_f32_16x16x32_bf16 v[64:67], a[128:131], a[236:239], v[64:67]
    buffer_store_dwordx4 v[108:111], v1, s[56:59], s39 offen offset:3072 sc1
    v_add3_u32 v112, v108, v109, v112
    v_mfma_f32_16x16x32_bf16 v[68:71], a[132:135], a[236:239], v[68:71]
    v_add3_u32 v112, v110, v111, v112
    v_mfma_f32_16x16x32_bf16 v[72:75], a[136:139], a[236:239], v[72:75]
    v_mfma_f32_16x16x32_bf16 v[76:79], a[140:143], a[236:239], v[76:79]
    v_mfma_f32_16x16x32_bf16 v[64:67], a[160:163], a[244:247], v[64:67]
    buffer_store_dword v112, v12, s[56:59], s39 offen sc1
    v_mfma_f32_16x16x32_bf16 v[68:71], a[164:167], a[244:247], v[68:71]
    v_mfma_f32_16x16x32_bf16 v[72:75], a[168:171], a[244:247], v[72:75]
    v_mfma_f32_16x16x32_bf16 v[76:79], a[172:175], a[244:247], v[76:79]
    v_mfma_f32_16x16x32_bf16 v[64:67], a[192:195], a[252:255], v[64:67]
    buffer_load_dwordx4 v[212:215], v21, s[56:59], s78 offen sc1
    v_mfma_f32_16x16x32_bf16 v[68:71], a[196:199], a[252:255], v[68:71]
    v_mfma_f32_16x16x32_bf16 v[72:75], a[200:203], a[252:255], v[72:75]
    v_mfma_f32_16x16x32_bf16 v[76:79], a[204:207], a[252:255], v[76:79]
    v_mfma_f32_16x16x32_bf16 v[80:83], a[16:19], v[236:239], 0
    buffer_load_dwordx4 v[220:223], v21, s[56:59], s79 offen sc1
    ds_write_b128 v24, v[64:67] offset:36864
    v_mfma_f32_16x16x32_bf16 v[84:87], a[20:23], v[236:239], 0
    v_mfma_f32_16x16x32_bf16 v[88:91], a[24:27], v[236:239], 0
    v_mfma_f32_16x16x32_bf16 v[92:95], a[28:31], v[236:239], 0
    v_mfma_f32_16x16x32_bf16 v[80:83], a[48:51], v[244:247], v[80:83]
    buffer_load_dwordx4 v[228:231], v21, s[56:59], s80 offen sc1
    ds_write_b128 v24, v[68:71] offset:37888
    v_mfma_f32_16x16x32_bf16 v[84:87], a[52:55], v[244:247], v[84:87]
    v_mfma_f32_16x16x32_bf16 v[88:91], a[56:59], v[244:247], v[88:91]
    v_mfma_f32_16x16x32_bf16 v[92:95], a[60:63], v[244:247], v[92:95]
    v_mfma_f32_16x16x32_bf16 v[80:83], a[80:83], v[252:255], v[80:83]
    buffer_load_dwordx4 v[176:179], v20, s[56:59], s74 offen sc1
    ds_write_b128 v24, v[72:75] offset:38912
    v_mfma_f32_16x16x32_bf16 v[84:87], a[84:87], v[252:255], v[84:87]
    v_mfma_f32_16x16x32_bf16 v[88:91], a[88:91], v[252:255], v[88:91]
    v_mfma_f32_16x16x32_bf16 v[92:95], a[92:95], v[252:255], v[92:95]
    v_mfma_f32_16x16x32_bf16 v[80:83], a[112:115], a[228:231], v[80:83]
    buffer_load_dwordx4 v[184:187], v20, s[56:59], s75 offen sc1
    ds_write_b128 v24, v[76:79] offset:39936
    v_mfma_f32_16x16x32_bf16 v[84:87], a[116:119], a[228:231], v[84:87]
    v_mfma_f32_16x16x32_bf16 v[88:91], a[120:123], a[228:231], v[88:91]
    v_mfma_f32_16x16x32_bf16 v[92:95], a[124:127], a[228:231], v[92:95]
    s_waitcnt lgkmcnt(0)
    s_barrier
    v_mfma_f32_16x16x32_bf16 v[80:83], a[144:147], a[236:239], v[80:83]
    buffer_load_dwordx4 v[192:195], v20, s[56:59], s76 offen sc1
    ds_read_b128 v[64:67], v27 offset:36864
    v_mfma_f32_16x16x32_bf16 v[84:87], a[148:151], a[236:239], v[84:87]
    ds_read_b128 v[68:71], v27 offset:37888
    v_mfma_f32_16x16x32_bf16 v[88:91], a[152:155], a[236:239], v[88:91]
    ds_read_b128 v[72:75], v27 offset:38912
    v_mfma_f32_16x16x32_bf16 v[92:95], a[156:159], a[236:239], v[92:95]
    ds_read_b128 v[76:79], v27 offset:39936
    v_mfma_f32_16x16x32_bf16 v[80:83], a[176:179], a[244:247], v[80:83]
    s_waitcnt vmcnt(18)
    v_max3_u32 v13, v232, v240, v248
    v_accvgpr_read_b32 v14, a224
    v_mfma_f32_16x16x32_bf16 v[84:87], a[180:183], a[244:247], v[84:87]
    v_max_u32 v13, v13, v14
    v_cmp_eq_u32 vcc, -1, v13
    v_mfma_f32_16x16x32_bf16 v[88:91], a[184:187], a[244:247], v[88:91]
    s_cbranch_vccnz ck_24s
ck_24r:
    buffer_load_dwordx4 v[200:203], v20, s[56:59], s77 offen sc1
    v_mfma_f32_16x16x32_bf16 v[92:95], a[188:191], a[244:247], v[92:95]
    v_mfma_f32_16x16x32_bf16 v[80:83], a[208:211], a[252:255], v[80:83]
    v_mfma_f32_16x16x32_bf16 v[84:87], a[212:215], a[252:255], v[84:87]
    v_mfma_f32_16x16x32_bf16 v[88:91], a[216:219], a[252:255], v[88:91]
    buffer_load_dwordx4 v[208:211], v20, s[56:59], s78 offen sc1
    v_mfma_f32_16x16x32_bf16 v[92:95], a[220:223], a[252:255], v[92:95]
    s_waitcnt lgkmcnt(0)
    v_mfma_f32_16x16x32_bf16 v[64:67], a[16:19], v[232:235], v[64:67]
    ds_write_b128 v24, v[80:83] offset:24576
    v_mfma_f32_16x16x32_bf16 v[68:71], a[20:23], v[232:235], v[68:71]
    v_mfma_f32_16x16x32_bf16 v[72:75], a[24:27], v[232:235], v[72:75]
    buffer_load_dwordx4 v[216:219], v20, s[56:59], s79 offen sc1
    v_mfma_f32_16x16x32_bf16 v[76:79], a[28:31], v[232:235], v[76:79]
    v_mfma_f32_16x16x32_bf16 v[64:67], a[48:51], v[240:243], v[64:67]
    ds_write_b128 v24, v[84:87] offset:25600
    v_mfma_f32_16x16x32_bf16 v[68:71], a[52:55], v[240:243], v[68:71]
    v_mfma_f32_16x16x32_bf16 v[72:75], a[56:59], v[240:243], v[72:75]
    buffer_load_dwordx4 v[224:227], v20, s[56:59], s80 offen sc1
    v_mfma_f32_16x16x32_bf16 v[76:79], a[60:63], v[240:243], v[76:79]
    v_mfma_f32_16x16x32_bf16 v[64:67], a[80:83], v[248:251], v[64:67]
    s_waitcnt vmcnt(19)
    v_accvgpr_read_b32 v14, a232
    v_accvgpr_read_b32 v15, a240
    v_mfma_f32_16x16x32_bf16 v[68:71], a[84:87], v[248:251], v[68:71]
    v_accvgpr_read_b32 v13, a248
    v_max3_u32 v13, v14, v15, v13
    v_mfma_f32_16x16x32_bf16 v[72:75], a[88:91], v[248:251], v[72:75]
    v_cmp_eq_u32 vcc, -1, v13
    s_cbranch_vccnz ck_25s
ck_25r:
    v_mfma_f32_16x16x32_bf16 v[76:79], a[92:95], v[248:251], v[76:79]
    buffer_load_dwordx4 v[236:239], v23, s[56:59], s74 offen sc1
    ds_write_b128 v24, v[88:91] offset:26624
    v_mfma_f32_16x16x32_bf16 v[64:67], a[112:115], a[224:227], v[64:67]
    v_mfma_f32_16x16x32_bf16 v[68:71], a[116:119], a[224:227], v[68:71]
    v_mfma_f32_16x16x32_bf16 v[72:75], a[120:123], a[224:227], v[72:75]
    v_mfma_f32_16x16x32_bf16 v[76:79], a[124:127], a[224:227], v[76:79]
    buffer_load_dwordx4 v[244:247], v23, s[56:59], s75 offen sc1
    ds_write_b128 v24, v[92:95] offset:27648
    v_mfma_f32_16x16x32_bf16 v[64:67], a[144:147], a[232:235], v[64:67]
    v_mfma_f32_16x16x32_bf16 v[68:71], a[148:151], a[232:235], v[68:71]
    v_mfma_f32_16x16x32_bf16 v[72:75], a[152:155], a[232:235], v[72:75]
    s_waitcnt lgkmcnt(0)
    s_barrier
    v_mfma_f32_16x16x32_bf16 v[76:79], a[156:159], a[232:235], v[76:79]
    buffer_load_dwordx4 v[252:255], v23, s[56:59], s76 offen sc1
    ds_read_b128 v[80:83], v27 offset:24576
    v_mfma_f32_16x16x32_bf16 v[64:67], a[176:179], a[240:243], v[64:67]
    ds_read_b128 v[84:87], v27 offset:25600
    v_mfma_f32_16x16x32_bf16 v[68:71], a[180:183], a[240:243], v[68:71]
    ds_read_b128 v[88:91], v27 offset:26624
    v_mfma_f32_16x16x32_bf16 v[72:75], a[184:187], a[240:243], v[72:75]
    ds_read_b128 v[92:95], v27 offset:27648
    v_mfma_f32_16x16x32_bf16 v[76:79], a[188:191], a[240:243], v[76:79]
    buffer_load_dwordx4 a[228:231], v23, s[56:59], s77 offen sc1
    v_mfma_f32_16x16x32_bf16 v[64:67], a[208:211], a[248:251], v[64:67]
    v_mfma_f32_16x16x32_bf16 v[68:71], a[212:215], a[248:251], v[68:71]
    v_mfma_f32_16x16x32_bf16 v[72:75], a[216:219], a[248:251], v[72:75]
    v_mfma_f32_16x16x32_bf16 v[76:79], a[220:223], a[248:251], v[76:79]
    buffer_load_dwordx4 a[236:239], v23, s[56:59], s78 offen sc1
    s_waitcnt lgkmcnt(0)
    v_mfma_f32_16x16x32_bf16 v[80:83], a[0:3], v[232:235], v[80:83]
    ds_write_b128 v24, v[64:67] offset:28672
    v_mfma_f32_16x16x32_bf16 v[84:87], a[4:7], v[232:235], v[84:87]
    v_mfma_f32_16x16x32_bf16 v[88:91], a[8:11], v[232:235], v[88:91]
    v_mfma_f32_16x16x32_bf16 v[92:95], a[12:15], v[232:235], v[92:95]
    buffer_load_dwordx4 a[244:247], v23, s[56:59], s79 offen sc1
    v_mfma_f32_16x16x32_bf16 v[80:83], a[32:35], v[240:243], v[80:83]
    ds_write_b128 v24, v[68:71] offset:29696
    v_mfma_f32_16x16x32_bf16 v[84:87], a[36:39], v[240:243], v[84:87]
    v_mfma_f32_16x16x32_bf16 v[88:91], a[40:43], v[240:243], v[88:91]
    v_mfma_f32_16x16x32_bf16 v[92:95], a[44:47], v[240:243], v[92:95]
    buffer_load_dwordx4 a[252:255], v23, s[56:59], s80 offen sc1
    v_mfma_f32_16x16x32_bf16 v[80:83], a[64:67], v[248:251], v[80:83]
    ds_write_b128 v24, v[72:75] offset:30720
    v_mfma_f32_16x16x32_bf16 v[84:87], a[68:71], v[248:251], v[84:87]
    v_mfma_f32_16x16x32_bf16 v[88:91], a[72:75], v[248:251], v[88:91]
    v_mfma_f32_16x16x32_bf16 v[92:95], a[76:79], v[248:251], v[92:95]
    buffer_load_dwordx4 v[232:235], v22, s[56:59], s74 offen sc1
    v_mfma_f32_16x16x32_bf16 v[80:83], a[96:99], a[224:227], v[80:83]
    ds_write_b128 v24, v[76:79] offset:31744
    v_mfma_f32_16x16x32_bf16 v[84:87], a[100:103], a[224:227], v[84:87]
    v_mfma_f32_16x16x32_bf16 v[88:91], a[104:107], a[224:227], v[88:91]
    v_mfma_f32_16x16x32_bf16 v[92:95], a[108:111], a[224:227], v[92:95]
    buffer_load_dwordx4 v[240:243], v22, s[56:59], s75 offen sc1
    v_mfma_f32_16x16x32_bf16 v[80:83], a[128:131], a[232:235], v[80:83]
    s_waitcnt lgkmcnt(0)
    s_barrier
    v_mfma_f32_16x16x32_bf16 v[84:87], a[132:135], a[232:235], v[84:87]
    ds_read_b128 v[64:67], v25 offset:28672
    v_mfma_f32_16x16x32_bf16 v[88:91], a[136:139], a[232:235], v[88:91]
    ds_read_b128 v[68:71], v25 offset:29696
    v_mfma_f32_16x16x32_bf16 v[92:95], a[140:143], a[232:235], v[92:95]
    buffer_load_dwordx4 v[248:251], v22, s[56:59], s76 offen sc1
    ds_read_b128 v[72:75], v25 offset:30720
    v_mfma_f32_16x16x32_bf16 v[80:83], a[160:163], a[240:243], v[80:83]
    s_waitcnt vmcnt(25)
    v_max3_u32 v13, v180, v188, v196
    v_max_u32 v13, v13, v204
    v_mfma_f32_16x16x32_bf16 v[84:87], a[164:167], a[240:243], v[84:87]
    v_cmp_eq_u32 vcc, -1, v13
    s_cbranch_vccnz ck_26s
ck_26r:
    v_mfma_f32_16x16x32_bf16 v[88:91], a[168:171], a[240:243], v[88:91]
    ds_read_b128 v[76:79], v25 offset:31744
    v_mfma_f32_16x16x32_bf16 v[92:95], a[172:175], a[240:243], v[92:95]
    buffer_load_dwordx4 a[224:227], v22, s[56:59], s77 offen sc1
    v_mfma_f32_16x16x32_bf16 v[80:83], a[192:195], a[248:251], v[80:83]
    v_mfma_f32_16x16x32_bf16 v[84:87], a[196:199], a[248:251], v[84:87]
    v_mfma_f32_16x16x32_bf16 v[88:91], a[200:203], a[248:251], v[88:91]
    v_mfma_f32_16x16x32_bf16 v[92:95], a[204:207], a[248:251], v[92:95]
    buffer_load_dwordx4 a[232:235], v22, s[56:59], s78 offen sc1
    v_mfma_f32_16x16x32_bf16 v[32:35], a[0:3], v[180:183], 0
    s_waitcnt lgkmcnt(0)
    v_add_f32 v96, v80, v64
    v_mfma_f32_16x16x32_bf16 v[36:39], a[4:7], v[180:183], 0
    v_add_f32 v97, v81, v65
    v_add_f32 v98, v82, v66
    v_mfma_f32_16x16x32_bf16 v[40:43], a[8:11], v[180:183], 0
    v_add_f32 v99, v83, v67
    v_mfma_f32_16x16x32_bf16 v[44:47], a[12:15], v[180:183], 0
    buffer_store_dwordx4 v[96:99], v1, s[56:59], s40 offen offset:0 sc1
    v_add3_u32 v112, v96, v97, s72
    v_mfma_f32_16x16x32_bf16 v[32:35], a[32:35], v[188:191], v[32:35]
    v_add3_u32 v112, v98, v99, v112
    v_add_f32 v100, v84, v68
    v_mfma_f32_16x16x32_bf16 v[36:39], a[36:39], v[188:191], v[36:39]
    v_add_f32 v101, v85, v69
    v_add_f32 v102, v86, v70
    v_mfma_f32_16x16x32_bf16 v[40:43], a[40:43], v[188:191], v[40:43]
    v_add_f32 v103, v87, v71
    v_mfma_f32_16x16x32_bf16 v[44:47], a[44:47], v[188:191], v[44:47]
    buffer_store_dwordx4 v[100:103], v1, s[56:59], s40 offen offset:1024 sc1
    v_add3_u32 v112, v100, v101, v112
    v_mfma_f32_16x16x32_bf16 v[32:35], a[64:67], v[196:199], v[32:35]
    s_waitcnt vmcnt(21)
    v_max3_u32 v13, v212, v220, v228
    v_cmp_eq_u32 vcc, -1, v13
    v_mfma_f32_16x16x32_bf16 v[36:39], a[68:71], v[196:199], v[36:39]
    s_cbranch_vccnz ck_27s
ck_27r:
    v_add3_u32 v112, v102, v103, v112
    v_mfma_f32_16x16x32_bf16 v[40:43], a[72:75], v[196:199], v[40:43]
    v_add_f32 v104, v88, v72
    v_add_f32 v105, v89, v73
    v_mfma_f32_16x16x32_bf16 v[44:47], a[76:79], v[196:199], v[44:47]
    v_add_f32 v106, v90, v74
    v_add_f32 v107, v91, v75
    v_mfma_f32_16x16x32_bf16 v[32:35], a[96:99], v[204:207], v[32:35]
    buffer_store_dwordx4 v[104:107], v1, s[56:59], s40 offen offset:2048 sc1
    v_add3_u32 v112, v104, v105, v112
    v_mfma_f32_16x16x32_bf16 v[36:39], a[100:103], v[204:207], v[36:39]
    v_add3_u32 v112, v106, v107, v112
    v_add_f32 v108, v92, v76
    v_mfma_f32_16x16x32_bf16 v[40:43], a[104:107], v[204:207], v[40:43]
    v_add_f32 v109, v93, v77
    v_add_f32 v110, v94, v78
    v_mfma_f32_16x16x32_bf16 v[44:47], a[108:111], v[204:207], v[44:47]
    v_add_f32 v111, v95, v79
    v_mfma_f32_16x16x32_bf16 v[32:35], a[128:131], v[212:215], v[32:35]
    buffer_store_dwordx4 v[108:111], v1, s[56:59], s40 offen offset:3072 sc1
    v_add3_u32 v112, v108, v109, v112
    v_mfma_f32_16x16x32_bf16 v[36:39], a[132:135], v[212:215], v[36:39]
    v_add3_u32 v112, v110, v111, v112
    v_mfma_f32_16x16x32_bf16 v[40:43], a[136:139], v[212:215], v[40:43]
    v_mfma_f32_16x16x32_bf16 v[44:47], a[140:143], v[212:215], v[44:47]
    v_mfma_f32_16x16x32_bf16 v[32:35], a[160:163], v[220:223], v[32:35]
    buffer_store_dword v112, v12, s[56:59], s40 offen sc1
    v_mfma_f32_16x16x32_bf16 v[36:39], a[164:167], v[220:223], v[36:39]
    v_mfma_f32_16x16x32_bf16 v[40:43], a[168:171], v[220:223], v[40:43]
    v_mfma_f32_16x16x32_bf16 v[44:47], a[172:175], v[220:223], v[44:47]
    v_mfma_f32_16x16x32_bf16 v[32:35], a[192:195], v[228:231], v[32:35]
    buffer_load_dwordx4 a[240:243], v22, s[56:59], s79 offen sc1
    v_mfma_f32_16x16x32_bf16 v[36:39], a[196:199], v[228:231], v[36:39]
    v_mfma_f32_16x16x32_bf16 v[40:43], a[200:203], v[228:231], v[40:43]
    v_mfma_f32_16x16x32_bf16 v[44:47], a[204:207], v[228:231], v[44:47]
    v_mfma_f32_16x16x32_bf16 v[48:51], a[16:19], v[180:183], 0
    buffer_load_dwordx4 a[248:251], v22, s[56:59], s80 offen sc1
    ds_write_b128 v24, v[32:35] offset:36864
    v_mfma_f32_16x16x32_bf16 v[52:55], a[20:23], v[180:183], 0
    v_mfma_f32_16x16x32_bf16 v[56:59], a[24:27], v[180:183], 0
    v_mfma_f32_16x16x32_bf16 v[60:63], a[28:31], v[180:183], 0
    v_mfma_f32_16x16x32_bf16 v[48:51], a[48:51], v[188:191], v[48:51]
    buffer_load_dwordx4 v[114:117], v1, s[56:59], s36 offen offset:0 sc1
    ds_write_b128 v24, v[36:39] offset:37888
    v_mfma_f32_16x16x32_bf16 v[52:55], a[52:55], v[188:191], v[52:55]
    v_mfma_f32_16x16x32_bf16 v[56:59], a[56:59], v[188:191], v[56:59]
    v_mfma_f32_16x16x32_bf16 v[60:63], a[60:63], v[188:191], v[60:63]
    v_mfma_f32_16x16x32_bf16 v[48:51], a[80:83], v[196:199], v[48:51]
    buffer_load_dwordx4 v[118:121], v1, s[56:59], s36 offen offset:1024 sc1
    ds_write_b128 v24, v[40:43] offset:38912
    v_mfma_f32_16x16x32_bf16 v[52:55], a[84:87], v[196:199], v[52:55]
    v_mfma_f32_16x16x32_bf16 v[56:59], a[88:91], v[196:199], v[56:59]
    v_mfma_f32_16x16x32_bf16 v[60:63], a[92:95], v[196:199], v[60:63]
    v_mfma_f32_16x16x32_bf16 v[48:51], a[112:115], v[204:207], v[48:51]
    buffer_load_dwordx4 v[122:125], v1, s[56:59], s36 offen offset:2048 sc1
    ds_write_b128 v24, v[44:47] offset:39936
    v_mfma_f32_16x16x32_bf16 v[52:55], a[116:119], v[204:207], v[52:55]
    v_mfma_f32_16x16x32_bf16 v[56:59], a[120:123], v[204:207], v[56:59]
    v_mfma_f32_16x16x32_bf16 v[60:63], a[124:127], v[204:207], v[60:63]
    s_waitcnt lgkmcnt(0)
    s_barrier
    v_mfma_f32_16x16x32_bf16 v[48:51], a[144:147], v[212:215], v[48:51]
    buffer_load_dwordx4 v[126:129], v1, s[56:59], s36 offen offset:3072 sc1
    ds_read_b128 v[32:35], v27 offset:36864
    v_mfma_f32_16x16x32_bf16 v[52:55], a[148:151], v[212:215], v[52:55]
    ds_read_b128 v[36:39], v27 offset:37888
    v_mfma_f32_16x16x32_bf16 v[56:59], a[152:155], v[212:215], v[56:59]
    ds_read_b128 v[40:43], v27 offset:38912
    v_mfma_f32_16x16x32_bf16 v[60:63], a[156:159], v[212:215], v[60:63]
    ds_read_b128 v[44:47], v27 offset:39936
    v_mfma_f32_16x16x32_bf16 v[48:51], a[176:179], v[220:223], v[48:51]
    s_waitcnt vmcnt(26)
    v_max3_u32 v13, v176, v184, v192
    v_max_u32 v13, v13, v200
    v_mfma_f32_16x16x32_bf16 v[52:55], a[180:183], v[220:223], v[52:55]
    v_cmp_eq_u32 vcc, -1, v13
    s_cbranch_vccnz ck_28s
ck_28r:
    v_mfma_f32_16x16x32_bf16 v[56:59], a[184:187], v[220:223], v[56:59]
    buffer_load_dword v130, v12, s[56:59], s36 offen sc1
    v_mfma_f32_16x16x32_bf16 v[60:63], a[188:191], v[220:223], v[60:63]
    v_mfma_f32_16x16x32_bf16 v[48:51], a[208:211], v[228:231], v[48:51]
    v_mfma_f32_16x16x32_bf16 v[52:55], a[212:215], v[228:231], v[52:55]
    v_mfma_f32_16x16x32_bf16 v[56:59], a[216:219], v[228:231], v[56:59]
    v_mfma_f32_16x16x32_bf16 v[60:63], a[220:223], v[228:231], v[60:63]
    s_waitcnt lgkmcnt(0)
    v_mfma_f32_16x16x32_bf16 v[32:35], a[16:19], v[176:179], v[32:35]
    ds_write_b128 v24, v[48:51] offset:24576
    v_mfma_f32_16x16x32_bf16 v[36:39], a[20:23], v[176:179], v[36:39]
    v_mfma_f32_16x16x32_bf16 v[40:43], a[24:27], v[176:179], v[40:43]
    v_mfma_f32_16x16x32_bf16 v[44:47], a[28:31], v[176:179], v[44:47]
    v_mfma_f32_16x16x32_bf16 v[32:35], a[48:51], v[184:187], v[32:35]
    ds_write_b128 v24, v[52:55] offset:25600
    v_mfma_f32_16x16x32_bf16 v[36:39], a[52:55], v[184:187], v[36:39]
    v_mfma_f32_16x16x32_bf16 v[40:43], a[56:59], v[184:187], v[40:43]
    v_mfma_f32_16x16x32_bf16 v[44:47], a[60:63], v[184:187], v[44:47]
    v_mfma_f32_16x16x32_bf16 v[32:35], a[80:83], v[192:195], v[32:35]
    s_waitcnt vmcnt(24)
    v_max3_u32 v13, v208, v216, v224
    v_cmp_eq_u32 vcc, -1, v13
    v_mfma_f32_16x16x32_bf16 v[36:39], a[84:87], v[192:195], v[36:39]
    s_cbranch_vccnz ck_29s
ck_29r:
    ds_write_b128 v24, v[56:59] offset:26624
    v_mfma_f32_16x16x32_bf16 v[40:43], a[88:91], v[192:195], v[40:43]
    v_mfma_f32_16x16x32_bf16 v[44:47], a[92:95], v[192:195], v[44:47]
    v_mfma_f32_16x16x32_bf16 v[32:35], a[112:115], v[200:203], v[32:35]
    v_mfma_f32_16x16x32_bf16 v[36:39], a[116:119], v[200:203], v[36:39]
    ds_write_b128 v24, v[60:63] offset:27648
    v_mfma_f32_16x16x32_bf16 v[40:43], a[120:123], v[200:203], v[40:43]
    v_mfma_f32_16x16x32_bf16 v[44:47], a[124:127], v[200:203], v[44:47]
    v_mfma_f32_16x16x32_bf16 v[32:35], a[144:147], v[208:211], v[32:35]
    s_waitcnt lgkmcnt(0)
    s_barrier
    v_mfma_f32_16x16x32_bf16 v[36:39], a[148:151], v[208:211], v[36:39]
    ds_read_b128 v[48:51], v27 offset:24576
    v_mfma_f32_16x16x32_bf16 v[40:43], a[152:155], v[208:211], v[40:43]
    ds_read_b128 v[52:55], v27 offset:25600
    v_mfma_f32_16x16x32_bf16 v[44:47], a[156:159], v[208:211], v[44:47]
    ds_read_b128 v[56:59], v27 offset:26624
    v_mfma_f32_16x16x32_bf16 v[32:35], a[176:179], v[216:219], v[32:35]
    ds_read_b128 v[60:63], v27 offset:27648
    v_mfma_f32_16x16x32_bf16 v[36:39], a[180:183], v[216:219], v[36:39]
    v_mfma_f32_16x16x32_bf16 v[40:43], a[184:187], v[216:219], v[40:43]
    v_mfma_f32_16x16x32_bf16 v[44:47], a[188:191], v[216:219], v[44:47]
    v_mfma_f32_16x16x32_bf16 v[32:35], a[208:211], v[224:227], v[32:35]
    v_mfma_f32_16x16x32_bf16 v[36:39], a[212:215], v[224:227], v[36:39]
    v_mfma_f32_16x16x32_bf16 v[40:43], a[216:219], v[224:227], v[40:43]
    v_mfma_f32_16x16x32_bf16 v[44:47], a[220:223], v[224:227], v[44:47]
    s_waitcnt lgkmcnt(0)
    v_mfma_f32_16x16x32_bf16 v[48:51], a[0:3], v[176:179], v[48:51]
    ds_write_b128 v24, v[32:35] offset:28672
    v_mfma_f32_16x16x32_bf16 v[52:55], a[4:7], v[176:179], v[52:55]
    v_mfma_f32_16x16x32_bf16 v[56:59], a[8:11], v[176:179], v[56:59]
    v_mfma_f32_16x16x32_bf16 v[60:63], a[12:15], v[176:179], v[60:63]
    v_mfma_f32_16x16x32_bf16 v[48:51], a[32:35], v[184:187], v[48:51]
    ds_write_b128 v24, v[36:39] offset:29696
    v_mfma_f32_16x16x32_bf16 v[52:55], a[36:39], v[184:187], v[52:55]
    v_mfma_f32_16x16x32_bf16 v[56:59], a[40:43], v[184:187], v[56:59]
    v_mfma_f32_16x16x32_bf16 v[60:63], a[44:47], v[184:187], v[60:63]
    v_mfma_f32_16x16x32_bf16 v[48:51], a[64:67], v[192:195], v[48:51]
    ds_write_b128 v24, v[40:43] offset:30720
    v_mfma_f32_16x16x32_bf16 v[52:55], a[68:71], v[192:195], v[52:55]
    v_mfma_f32_16x16x32_bf16 v[56:59], a[72:75], v[192:195], v[56:59]
    v_mfma_f32_16x16x32_bf16 v[60:63], a[76:79], v[192:195], v[60:63]
    v_mfma_f32_16x16x32_bf16 v[48:51], a[96:99], v[200:203], v[48:51]
    ds_write_b128 v24, v[44:47] offset:31744
    v_mfma_f32_16x16x32_bf16 v[52:55], a[100:103], v[200:203], v[52:55]
    v_mfma_f32_16x16x32_bf16 v[56:59], a[104:107], v[200:203], v[56:59]
    v_mfma_f32_16x16x32_bf16 v[60:63], a[108:111], v[200:203], v[60:63]
    s_waitcnt lgkmcnt(0)
    s_barrier
    v_mfma_f32_16x16x32_bf16 v[48:51], a[128:131], v[208:211], v[48:51]
    ds_read_b128 v[32:35], v25 offset:28672
    v_mfma_f32_16x16x32_bf16 v[52:55], a[132:135], v[208:211], v[52:55]
    ds_read_b128 v[36:39], v25 offset:29696
    v_mfma_f32_16x16x32_bf16 v[56:59], a[136:139], v[208:211], v[56:59]
    ds_read_b128 v[40:43], v25 offset:30720
    v_mfma_f32_16x16x32_bf16 v[60:63], a[140:143], v[208:211], v[60:63]
    ds_read_b128 v[44:47], v25 offset:31744
    v_mfma_f32_16x16x32_bf16 v[48:51], a[160:163], v[216:219], v[48:51]
    s_waitcnt vmcnt(20)
    v_max3_u32 v13, v236, v244, v252
    v_accvgpr_read_b32 v14, a228
    v_mfma_f32_16x16x32_bf16 v[52:55], a[164:167], v[216:219], v[52:55]
    v_max_u32 v13, v13, v14
    v_cmp_eq_u32 vcc, -1, v13
    v_mfma_f32_16x16x32_bf16 v[56:59], a[168:171], v[216:219], v[56:59]
    s_cbranch_vccnz ck_30s
ck_30r:
    v_mfma_f32_16x16x32_bf16 v[60:63], a[172:175], v[216:219], v[60:63]
    v_mfma_f32_16x16x32_bf16 v[48:51], a[192:195], v[224:227], v[48:51]
    v_mfma_f32_16x16x32_bf16 v[52:55], a[196:199], v[224:227], v[52:55]
    v_mfma_f32_16x16x32_bf16 v[56:59], a[200:203], v[224:227], v[56:59]
    v_mfma_f32_16x16x32_bf16 v[60:63], a[204:207], v[224:227], v[60:63]
    v_mfma_f32_16x16x32_bf16 v[64:67], a[0:3], v[236:239], 0
    s_waitcnt lgkmcnt(0)
    v_add_f32 v96, v48, v32
    v_add_f32 v97, v49, v33
    v_mfma_f32_16x16x32_bf16 v[68:71], a[4:7], v[236:239], 0
    v_add_f32 v98, v50, v34
    v_add_f32 v99, v51, v35
    buffer_store_dwordx4 v[96:99], v1, s[56:59], s41 offen offset:0 sc1
    v_mfma_f32_16x16x32_bf16 v[72:75], a[8:11], v[236:239], 0
    v_add3_u32 v112, v96, v97, s72
    v_add3_u32 v112, v98, v99, v112
    v_add_f32 v100, v52, v36
    v_mfma_f32_16x16x32_bf16 v[76:79], a[12:15], v[236:239], 0
    v_add_f32 v101, v53, v37
    v_add_f32 v102, v54, v38
    v_add_f32 v103, v55, v39
    v_mfma_f32_16x16x32_bf16 v[64:67], a[32:35], v[244:247], v[64:67]
    buffer_store_dwordx4 v[100:103], v1, s[56:59], s41 offen offset:1024 sc1
    v_add3_u32 v112, v100, v101, v112
    v_add3_u32 v112, v102, v103, v112
    v_mfma_f32_16x16x32_bf16 v[68:71], a[36:39], v[244:247], v[68:71]
    v_add_f32 v104, v56, v40
    v_add_f32 v105, v57, v41
    v_add_f32 v106, v58, v42
    v_mfma_f32_16x16x32_bf16 v[72:75], a[40:43], v[244:247], v[72:75]
    v_add_f32 v107, v59, v43
    buffer_store_dwordx4 v[104:107], v1, s[56:59], s41 offen offset:2048 sc1
    v_add3_u32 v112, v104, v105, v112
    v_mfma_f32_16x16x32_bf16 v[76:79], a[44:47], v[244:247], v[76:79]
    v_add3_u32 v112, v106, v107, v112
    v_add_f32 v108, v60, v44
    v_add_f32 v109, v61, v45
    v_mfma_f32_16x16x32_bf16 v[64:67], a[64:67], v[252:255], v[64:67]
    s_waitcnt vmcnt(20)
    v_accvgpr_read_b32 v14, a236
    v_accvgpr_read_b32 v15, a244
    v_add_f32 v110, v62, v46
    v_mfma_f32_16x16x32_bf16 v[68:71], a[68:71], v[252:255], v[68:71]
    v_accvgpr_read_b32 v13, a252
    v_max3_u32 v13, v14, v15, v13
    v_add_f32 v111, v63, v47
    v_mfma_f32_16x16x32_bf16 v[72:75], a[72:75], v[252:255], v[72:75]
    v_cmp_eq_u32 vcc, -1, v13
    s_cbranch_vccnz ck_31s
ck_31r:
    buffer_store_dwordx4 v[108:111], v1, s[56:59], s41 offen offset:3072 sc1
    v_mfma_f32_16x16x32_bf16 v[76:79], a[76:79], v[252:255], v[76:79]
    v_add3_u32 v112, v108, v109, v112
    v_add3_u32 v112, v110, v111, v112
    v_mfma_f32_16x16x32_bf16 v[64:67], a[96:99], a[228:231], v[64:67]
    buffer_store_dword v112, v12, s[56:59], s41 offen sc1
    v_mfma_f32_16x16x32_bf16 v[68:71], a[100:103], a[228:231], v[68:71]
    v_mfma_f32_16x16x32_bf16 v[72:75], a[104:107], a[228:231], v[72:75]
    v_mfma_f32_16x16x32_bf16 v[76:79], a[108:111], a[228:231], v[76:79]
    v_mfma_f32_16x16x32_bf16 v[64:67], a[128:131], a[236:239], v[64:67]
    v_mfma_f32_16x16x32_bf16 v[68:71], a[132:135], a[236:239], v[68:71]
    v_mfma_f32_16x16x32_bf16 v[72:75], a[136:139], a[236:239], v[72:75]
    v_mfma_f32_16x16x32_bf16 v[76:79], a[140:143], a[236:239], v[76:79]
    v_mfma_f32_16x16x32_bf16 v[64:67], a[160:163], a[244:247], v[64:67]
    v_mfma_f32_16x16x32_bf16 v[68:71], a[164:167], a[244:247], v[68:71]
    v_mfma_f32_16x16x32_bf16 v[72:75], a[168:171], a[244:247], v[72:75]
    v_mfma_f32_16x16x32_bf16 v[76:79], a[172:175], a[244:247], v[76:79]
    v_mfma_f32_16x16x32_bf16 v[64:67], a[192:195], a[252:255], v[64:67]
    buffer_load_dwordx4 v[132:135], v1, s[56:59], s37 offen offset:0 sc1
    v_mfma_f32_16x16x32_bf16 v[68:71], a[196:199], a[252:255], v[68:71]
    v_mfma_f32_16x16x32_bf16 v[72:75], a[200:203], a[252:255], v[72:75]
    v_mfma_f32_16x16x32_bf16 v[76:79], a[204:207], a[252:255], v[76:79]
    v_mfma_f32_16x16x32_bf16 v[80:83], a[16:19], v[236:239], 0
    buffer_load_dwordx4 v[136:139], v1, s[56:59], s37 offen offset:1024 sc1
    ds_write_b128 v24, v[64:67] offset:36864
    v_mfma_f32_16x16x32_bf16 v[84:87], a[20:23], v[236:239], 0
    v_mfma_f32_16x16x32_bf16 v[88:91], a[24:27], v[236:239], 0
    v_mfma_f32_16x16x32_bf16 v[92:95], a[28:31], v[236:239], 0
    v_mfma_f32_16x16x32_bf16 v[80:83], a[48:51], v[244:247], v[80:83]
    buffer_load_dwordx4 v[140:143], v1, s[56:59], s37 offen offset:2048 sc1
    ds_write_b128 v24, v[68:71] offset:37888
    v_mfma_f32_16x16x32_bf16 v[84:87], a[52:55], v[244:247], v[84:87]
    v_mfma_f32_16x16x32_bf16 v[88:91], a[56:59], v[244:247], v[88:91]
    v_mfma_f32_16x16x32_bf16 v[92:95], a[60:63], v[244:247], v[92:95]
    v_mfma_f32_16x16x32_bf16 v[80:83], a[80:83], v[252:255], v[80:83]
    buffer_load_dwordx4 v[144:147], v1, s[56:59], s37 offen offset:3072 sc1
    ds_write_b128 v24, v[72:75] offset:38912
    v_mfma_f32_16x16x32_bf16 v[84:87], a[84:87], v[252:255], v[84:87]
    v_mfma_f32_16x16x32_bf16 v[88:91], a[88:91], v[252:255], v[88:91]
    v_mfma_f32_16x16x32_bf16 v[92:95], a[92:95], v[252:255], v[92:95]
    v_mfma_f32_16x16x32_bf16 v[80:83], a[112:115], a[228:231], v[80:83]
    buffer_load_dword v148, v12, s[56:59], s37 offen sc1
    ds_write_b128 v24, v[76:79] offset:39936
    v_mfma_f32_16x16x32_bf16 v[84:87], a[116:119], a[228:231], v[84:87]
    v_mfma_f32_16x16x32_bf16 v[88:91], a[120:123], a[228:231], v[88:91]
    v_mfma_f32_16x16x32_bf16 v[92:95], a[124:127], a[228:231], v[92:95]
    s_waitcnt lgkmcnt(0)
    s_barrier
    v_mfma_f32_16x16x32_bf16 v[80:83], a[144:147], a[236:239], v[80:83]
    ds_read_b128 v[64:67], v27 offset:36864
    v_mfma_f32_16x16x32_bf16 v[84:87], a[148:151], a[236:239], v[84:87]
    ds_read_b128 v[68:71], v27 offset:37888
    v_mfma_f32_16x16x32_bf16 v[88:91], a[152:155], a[236:239], v[88:91]
    ds_read_b128 v[72:75], v27 offset:38912
    v_mfma_f32_16x16x32_bf16 v[92:95], a[156:159], a[236:239], v[92:95]
    ds_read_b128 v[76:79], v27 offset:39936
    v_mfma_f32_16x16x32_bf16 v[80:83], a[176:179], a[244:247], v[80:83]
    s_waitcnt vmcnt(23)
    v_max3_u32 v13, v232, v240, v248
    v_accvgpr_read_b32 v14, a224
    v_mfma_f32_16x16x32_bf16 v[84:87], a[180:183], a[244:247], v[84:87]
    v_max_u32 v13, v13, v14
    v_cmp_eq_u32 vcc, -1, v13
    v_mfma_f32_16x16x32_bf16 v[88:91], a[184:187], a[244:247], v[88:91]
    s_cbranch_vccnz ck_32s
ck_32r:
    v_mfma_f32_16x16x32_bf16 v[92:95], a[188:191], a[244:247], v[92:95]
    v_mfma_f32_16x16x32_bf16 v[80:83], a[208:211], a[252:255], v[80:83]
    v_mfma_f32_16x16x32_bf16 v[84:87], a[212:215], a[252:255], v[84:87]
    v_mfma_f32_16x16x32_bf16 v[88:91], a[216:219], a[252:255], v[88:91]
    v_mfma_f32_16x16x32_bf16 v[92:95], a[220:223], a[252:255], v[92:95]
    s_waitcnt lgkmcnt(0)
    v_mfma_f32_16x16x32_bf16 v[64:67], a[16:19], v[232:235], v[64:67]
    ds_write_b128 v24, v[80:83] offset:24576
    v_mfma_f32_16x16x32_bf16 v[68:71], a[20:23], v[232:235], v[68:71]
    v_mfma_f32_16x16x32_bf16 v[72:75], a[24:27], v[232:235], v[72:75]
    v_mfma_f32_16x16x32_bf16 v[76:79], a[28:31], v[232:235], v[76:79]
    v_mfma_f32_16x16x32_bf16 v[64:67], a[48:51], v[240:243], v[64:67]
    ds_write_b128 v24, v[84:87] offset:25600
    v_mfma_f32_16x16x32_bf16 v[68:71], a[52:55], v[240:243], v[68:71]
    v_mfma_f32_16x16x32_bf16 v[72:75], a[56:59], v[240:243], v[72:75]
    v_mfma_f32_16x16x32_bf16 v[76:79], a[60:63], v[240:243], v[76:79]
    v_mfma_f32_16x16x32_bf16 v[64:67], a[80:83], v[248:251], v[64:67]
    s_waitcnt vmcnt(15)
    v_accvgpr_read_b32 v14, a232
    v_accvgpr_read_b32 v15, a240
    v_mfma_f32_16x16x32_bf16 v[68:71], a[84:87], v[248:251], v[68:71]
    v_accvgpr_read_b32 v13, a248
    v_max3_u32 v13, v14, v15, v13
    v_mfma_f32_16x16x32_bf16 v[72:75], a[88:91], v[248:251], v[72:75]
    v_cmp_eq_u32 vcc, -1, v13
    s_cbranch_vccnz ck_33s
ck_33r:
    v_mfma_f32_16x16x32_bf16 v[76:79], a[92:95], v[248:251], v[76:79]
    ds_write_b128 v24, v[88:91] offset:26624
    v_mfma_f32_16x16x32_bf16 v[64:67], a[112:115], a[224:227], v[64:67]
    v_mfma_f32_16x16x32_bf16 v[68:71], a[116:119], a[224:227], v[68:71]
    v_mfma_f32_16x16x32_bf16 v[72:75], a[120:123], a[224:227], v[72:75]
    v_mfma_f32_16x16x32_bf16 v[76:79], a[124:127], a[224:227], v[76:79]
    ds_write_b128 v24, v[92:95] offset:27648
    v_mfma_f32_16x16x32_bf16 v[64:67], a[144:147], a[232:235], v[64:67]
    v_mfma_f32_16x16x32_bf16 v[68:71], a[148:151], a[232:235], v[68:71]
    v_mfma_f32_16x16x32_bf16 v[72:75], a[152:155], a[232:235], v[72:75]
    s_waitcnt lgkmcnt(0)
    s_barrier
    v_mfma_f32_16x16x32_bf16 v[76:79], a[156:159], a[232:235], v[76:79]
    ds_read_b128 v[80:83], v27 offset:24576
    v_mfma_f32_16x16x32_bf16 v[64:67], a[176:179], a[240:243], v[64:67]
    ds_read_b128 v[84:87], v27 offset:25600
    v_mfma_f32_16x16x32_bf16 v[68:71], a[180:183], a[240:243], v[68:71]
    ds_read_b128 v[88:91], v27 offset:26624
    v_mfma_f32_16x16x32_bf16 v[72:75], a[184:187], a[240:243], v[72:75]
    ds_read_b128 v[92:95], v27 offset:27648
    v_mfma_f32_16x16x32_bf16 v[76:79], a[188:191], a[240:243], v[76:79]
    v_mfma_f32_16x16x32_bf16 v[64:67], a[208:211], a[248:251], v[64:67]
    buffer_load_dwordx4 v[150:153], v1, s[56:59], s38 offen offset:0 sc1
    v_mfma_f32_16x16x32_bf16 v[68:71], a[212:215], a[248:251], v[68:71]
    v_mfma_f32_16x16x32_bf16 v[72:75], a[216:219], a[248:251], v[72:75]
    v_mfma_f32_16x16x32_bf16 v[76:79], a[220:223], a[248:251], v[76:79]
    s_waitcnt lgkmcnt(0)
    v_mfma_f32_16x16x32_bf16 v[80:83], a[0:3], v[232:235], v[80:83]
    buffer_load_dwordx4 v[154:157], v1, s[56:59], s38 offen offset:1024 sc1
    ds_write_b128 v24, v[64:67] offset:28672
    v_mfma_f32_16x16x32_bf16 v[84:87], a[4:7], v[232:235], v[84:87]
    v_mfma_f32_16x16x32_bf16 v[88:91], a[8:11], v[232:235], v[88:91]
    v_mfma_f32_16x16x32_bf16 v[92:95], a[12:15], v[232:235], v[92:95]
    v_mfma_f32_16x16x32_bf16 v[80:83], a[32:35], v[240:243], v[80:83]
    buffer_load_dwordx4 v[158:161], v1, s[56:59], s38 offen offset:2048 sc1
    ds_write_b128 v24, v[68:71] offset:29696
    v_mfma_f32_16x16x32_bf16 v[84:87], a[36:39], v[240:243], v[84:87]
    v_mfma_f32_16x16x32_bf16 v[88:91], a[40:43], v[240:243], v[88:91]
    v_mfma_f32_16x16x32_bf16 v[92:95], a[44:47], v[240:243], v[92:95]
    v_mfma_f32_16x16x32_bf16 v[80:83], a[64:67], v[248:251], v[80:83]
    buffer_load_dwordx4 v[162:165], v1, s[56:59], s38 offen offset:3072 sc1
    ds_write_b128 v24, v[72:75] offset:30720
    v_mfma_f32_16x16x32_bf16 v[84:87], a[68:71], v[248:251], v[84:87]
    v_mfma_f32_16x16x32_bf16 v[88:91], a[72:75], v[248:251], v[88:91]
    v_mfma_f32_16x16x32_bf16 v[92:95], a[76:79], v[248:251], v[92:95]
    v_mfma_f32_16x16x32_bf16 v[80:83], a[96:99], a[224:227], v[80:83]
    buffer_load_dword v166, v12, s[56:59], s38 offen sc1
    ds_write_b128 v24, v[76:79] offset:31744
    v_mfma_f32_16x16x32_bf16 v[84:87], a[100:103], a[224:227], v[84:87]
    v_mfma_f32_16x16x32_bf16 v[88:91], a[104:107], a[224:227], v[88:91]
    v_mfma_f32_16x16x32_bf16 v[92:95], a[108:111], a[224:227], v[92:95]
    s_waitcnt lgkmcnt(0)
    s_barrier
    v_mfma_f32_16x16x32_bf16 v[80:83], a[128:131], a[232:235], v[80:83]
    ds_read_b128 v[64:67], v25 offset:28672
    v_mfma_f32_16x16x32_bf16 v[84:87], a[132:135], a[232:235], v[84:87]
    ds_read_b128 v[68:71], v25 offset:29696
    v_mfma_f32_16x16x32_bf16 v[88:91], a[136:139], a[232:235], v[88:91]
    ds_read_b128 v[72:75], v25 offset:30720
    v_mfma_f32_16x16x32_bf16 v[92:95], a[140:143], a[232:235], v[92:95]
    ds_read_b128 v[76:79], v25 offset:31744
    v_mfma_f32_16x16x32_bf16 v[80:83], a[160:163], a[240:243], v[80:83]
    v_mfma_f32_16x16x32_bf16 v[84:87], a[164:167], a[240:243], v[84:87]
    v_mfma_f32_16x16x32_bf16 v[88:91], a[168:171], a[240:243], v[88:91]
    v_mfma_f32_16x16x32_bf16 v[92:95], a[172:175], a[240:243], v[92:95]
    v_mfma_f32_16x16x32_bf16 v[80:83], a[192:195], a[248:251], v[80:83]
    v_mfma_f32_16x16x32_bf16 v[84:87], a[196:199], a[248:251], v[84:87]
    v_mfma_f32_16x16x32_bf16 v[88:91], a[200:203], a[248:251], v[88:91]
    v_mfma_f32_16x16x32_bf16 v[92:95], a[204:207], a[248:251], v[92:95]
    s_waitcnt vmcnt(15)
    s_mov_b32 s85, 30000
rk_34:
    v_add3_u32 v131, v114, v115, s72
    v_add3_u32 v131, v116, v117, v131
    v_add3_u32 v131, v118, v119, v131
    v_add3_u32 v131, v120, v121, v131
    v_add3_u32 v131, v122, v123, v131
    v_add3_u32 v131, v124, v125, v131
    v_add3_u32 v131, v126, v127, v131
    v_add3_u32 v131, v128, v129, v131
    v_cmp_ne_u32 vcc, v131, v130
    s_cbranch_vccz rk_34o
    buffer_load_dwordx4 v[114:117], v1, s[56:59], s36 offen offset:0 sc1
    buffer_load_dwordx4 v[118:121], v1, s[56:59], s36 offen offset:1024 sc1
    buffer_load_dwordx4 v[122:125], v1, s[56:59], s36 offen offset:2048 sc1
    buffer_load_dwordx4 v[126:129], v1, s[56:59], s36 offen offset:3072 sc1
    buffer_load_dword v130, v12, s[56:59], s36 offen sc1
    s_sub_u32 s85, s85, 1
    s_waitcnt vmcnt(0)
    s_cbranch_scc0 rk_34
rk_34o:
    s_waitcnt vmcnt(5)
    s_mov_b32 s85, 30000
rk_35:
    v_add3_u32 v149, v132, v133, s72
    v_add3_u32 v149, v134, v135, v149
    v_add3_u32 v149, v136, v137, v149
    v_add3_u32 v149, v138, v139, v149
    v_add3_u32 v149, v140, v141, v149
    v_add3_u32 v149, v142, v143, v149
    v_add3_u32 v149, v144, v145, v149
    v_add3_u32 v149, v146, v147, v149
    v_cmp_ne_u32 vcc, v149, v148
    s_cbranch_vccz rk_35o
    buffer_load_dwordx4 v[132:135], v1, s[56:59], s37 offen offset:0 sc1
    buffer_load_dwordx4 v[136:139], v1, s[56:59], s37 offen offset:1024 sc1
    buffer_load_dwordx4 v[140:143], v1, s[56:59], s37 offen offset:2048 sc1
    buffer_load_dwordx4 v[144:147], v1, s[56:59], s37 offen offset:3072 sc1
    buffer_load_dword v148, v12, s[56:59], s37 offen sc1
    s_sub_u32 s85, s85, 1
    s_waitcnt vmcnt(0)
    s_cbranch_scc0 rk_35
rk_35o:
    v_pk_add_f32 v[32:33], v[114:115], v[132:133]
    v_pk_add_f32 v[34:35], v[116:117], v[134:135]
    v_pk_add_f32 v[36:37], v[118:119], v[136:137]
    v_pk_add_f32 v[38:39], v[120:121], v[138:139]
    v_pk_add_f32 v[40:41], v[122:123], v[140:141]
    v_pk_add_f32 v[42:43], v[124:125], v[142:143]
    v_pk_add_f32 v[44:45], v[126:127], v[144:145]
    v_pk_add_f32 v[46:47], v[128:129], v[146:147]
    s_waitcnt lgkmcnt(0)
    v_pk_add_f32 v[80:81], v[80:81], v[64:65]
    v_pk_add_f32 v[82:83], v[82:83], v[66:67]
    v_pk_add_f32 v[84:85], v[84:85], v[68:69]
    v_pk_add_f32 v[86:87], v[86:87], v[70:71]
    v_pk_add_f32 v[88:89], v[88:89], v[72:73]
    v_pk_add_f32 v[90:91], v[90:91], v[74:75]
    v_pk_add_f32 v[92:93], v[92:93], v[76:77]
    v_pk_add_f32 v[94:95], v[94:95], v[78:79]
    v_pk_add_f32 v[80:81], v[80:81], v[32:33]
    v_pk_add_f32 v[82:83], v[82:83], v[34:35]
    v_pk_add_f32 v[84:85], v[84:85], v[36:37]
    v_pk_add_f32 v[86:87], v[86:87], v[38:39]
    v_pk_add_f32 v[88:89], v[88:89], v[40:41]
    v_pk_add_f32 v[90:91], v[90:91], v[42:43]
    v_pk_add_f32 v[92:93], v[92:93], v[44:45]
    v_pk_add_f32 v[94:95], v[94:95], v[46:47]
    s_waitcnt vmcnt(0)
    s_mov_b32 s85, 30000
rk_36:
    v_add3_u32 v167, v150, v151, s72
    v_add3_u32 v167, v152, v153, v167
    v_add3_u32 v167, v154, v155, v167
    v_add3_u32 v167, v156, v157, v167
    v_add3_u32 v167, v158, v159, v167
    v_add3_u32 v167, v160, v161, v167
    v_add3_u32 v167, v162, v163, v167
    v_add3_u32 v167, v164, v165, v167
    v_cmp_ne_u32 vcc, v167, v166
    s_cbranch_vccz rk_36o
    buffer_load_dwordx4 v[150:153], v1, s[56:59], s38 offen offset:0 sc1
    buffer_load_dwordx4 v[154:157], v1, s[56:59], s38 offen offset:1024 sc1
    buffer_load_dwordx4 v[158:161], v1, s[56:59], s38 offen offset:2048 sc1
    buffer_load_dwordx4 v[162:165], v1, s[56:59], s38 offen offset:3072 sc1
    buffer_load_dword v166, v12, s[56:59], s38 offen sc1
    s_sub_u32 s85, s85, 1
    s_waitcnt vmcnt(0)
    s_cbranch_scc0 rk_36
rk_36o:
    v_pk_add_f32 v[80:81], v[80:81], v[150:151]
    v_pk_add_f32 v[82:83], v[82:83], v[152:153]
    v_pk_add_f32 v[84:85], v[84:85], v[154:155]
    v_pk_add_f32 v[86:87], v[86:87], v[156:157]
    v_cvt_pk_bf16_f32 v32, v80, v81
    v_cvt_pk_bf16_f32 v33, v82, v83
    v_cvt_pk_bf16_f32 v34, v84, v85
    v_cvt_pk_bf16_f32 v35, v86, v87
    buffer_store_dwordx4 v[32:35], v28, s[52:55], s31 offen offset:0 sc1
    v_pk_add_f32 v[88:89], v[88:89], v[158:159]
    v_pk_add_f32 v[90:91], v[90:91], v[160:161]
    v_pk_add_f32 v[92:93], v[92:93], v[162:163]
    v_pk_add_f32 v[94:95], v[94:95], v[164:165]
    v_cvt_pk_bf16_f32 v36, v88, v89
    v_cvt_pk_bf16_f32 v37, v90, v91
    v_cvt_pk_bf16_f32 v38, v92, v93
    v_cvt_pk_bf16_f32 v39, v94, v95
    buffer_store_dwordx4 v[36:39], v28, s[52:55], s31 offen offset:64 sc1
kfin:
    s_endpgm
cls_S:
    s_mov_b32 s7, s69
    s_and_b32 s5, s84, 6
    s_lshr_b32 s82, s7, 1
    s_add_u32 s5, s5, s82
    s_and_b32 s82, s84, 1
    s_and_b32 s69, s7, 1
    s_lshl1_add_u32 s69, s82, s69
    v_lshrrev_b32 v28, 3, v0
    v_and_b32 v29, 6, v28
    v_and_b32 v30, 7, v0
    v_xor_b32 v29, v29, v30
    v_lshlrev_b32 v29, 4, v29
    v_lshl_add_u32 v4, v28, 11, v29
    v_add_u32 v5, 15360, v4
    v_add_u32 v6, 30720, v4
    v_add_u32 v7, 46080, v4
    s_lshr_b32 s82, s68, 1
    s_lshl1_add_u32 s82, s69, s82
    s_lshl_b32 s3, s82, 16
    s_lshl_b32 s82, s68, 9
    s_add_u32 s3, s3, s82
    s_lshl_b32 s4, s68, 19
    s_lshl_b32 s82, s5, 8
    s_add_u32 s4, s4, s82
    v_mov_b32 v124, -1
    v_mov_b32 v125, -1
    v_mov_b32 v126, -1
    v_mov_b32 v127, -1
    s_lshl2_add_u32 s82, s69, s68
    s_lshl_b32 s82, s82, 3
    s_add_u32 s82, s82, s5
    s_lshl_b32 s6, s82, 12
    s_waitcnt lgkmcnt(0)
    s_mov_b64 s[28:29], s[8:9]
    s_mov_b32 s30, 524288
    s_mov_b32 s31, 0x20000
    s_mov_b64 s[44:45], s[16:17]
    s_mov_b32 s46, 2097152
    s_mov_b32 s47, 0x20000
    s_mov_b64 s[56:57], s[24:25]
    s_mov_b32 s58, 33554432
    s_mov_b32 s59, 0x20000
    buffer_store_dwordx4 v[124:127], v1, s[56:59], s6 offen offset:0 sc1
    buffer_store_dwordx4 v[124:127], v1, s[56:59], s6 offen offset:1024 sc1
    buffer_store_dwordx4 v[124:127], v1, s[56:59], s6 offen offset:2048 sc1
    buffer_store_dwordx4 v[124:127], v1, s[56:59], s6 offen offset:3072 sc1
    s_add_u32 s82, s7, 0
    s_and_b32 s82, s82, 3
    s_lshl_b32 s82, s82, 17
    s_add_u32 s26, s82, s4
    s_add_u32 m0, s81, 0
    s_nop 0
    buffer_load_dwordx4 v4, s[44:47], s26 offen offset:0 lds
    buffer_load_dwordx4 v5, s[44:47], s26 offen offset:1024 lds
    buffer_load_dwordx4 v6, s[44:47], s26 offen offset:2048 lds
    buffer_load_dwordx4 v7, s[44:47], s26 offen offset:3072 lds
    s_add_u32 s82, s7, 0
    s_and_b32 s82, s82, 3
    s_lshl_b32 s82, s82, 7
    s_add_u32 s26, s82, s3
    s_add_u32 m0, s81, 4096
    s_nop 0
    buffer_load_dwordx4 v4, s[28:31], s26 offen offset:0 lds
    buffer_load_dwordx4 v5, s[28:31], s26 offen offset:1024 lds
    buffer_load_dwordx4 v6, s[28:31], s26 offen offset:2048 lds
    buffer_load_dwordx4 v7, s[28:31], s26 offen offset:3072 lds
    s_add_u32 s82, s7, 0
    s_and_b32 s82, s82, 3
    s_lshl_b32 s82, s82, 7
    s_add_u32 s26, s82, s3
    s_xor_b32 s26, s26, 65536
    s_add_u32 m0, s81, 8192
    s_nop 0
    buffer_load_dwordx4 v4, s[28:31], s26 offen offset:0 lds
    buffer_load_dwordx4 v5, s[28:31], s26 offen offset:1024 lds
    buffer_load_dwordx4 v6, s[28:31], s26 offen offset:2048 lds
    buffer_load_dwordx4 v7, s[28:31], s26 offen offset:3072 lds
    s_mov_b64 s[60:61], s[22:23]
    s_mov_b32 s62, 256
    s_mov_b32 s63, 0x20000
    s_mov_b64 s[48:49], s[18:19]
    s_mov_b32 s50, 25690112
    s_mov_b32 s51, 0x20000
    v_lshrrev_b32 v28, 2, v0
    v_and_b32 v29, 6, v28
    v_bfe_u32 v30, v0, 1, 1
    v_or_b32 v29, v29, v30
    v_lshlrev_b32 v29, 4, v29
    v_lshl_add_u32 v29, v28, 7, v29
    v_and_b32 v30, 1, v0
    v_lshl_add_u32 v8, v30, 3, v29
    v_xor_b32 v9, 32, v8
    v_xor_b32 v10, 64, v8
    v_xor_b32 v11, 96, v8
    v_add_u32 v8, s81, v8
    v_add_u32 v9, s81, v9
    v_add_u32 v10, s81, v10
    v_add_u32 v11, s81, v11
    v_and_b32 v28, 15, v0
    v_lshrrev_b32 v29, 4, v0
    v_lshlrev_b32 v16, 7, v28
    v_and_b32 v30, 6, v28
    v_lshrrev_b32 v31, 1, v29
    v_or_b32 v30, v30, v31
    v_lshl_add_u32 v16, v30, 4, v16
    v_and_b32 v30, 1, v29
    v_lshl_add_u32 v16, v30, 3, v16
    s_and_b32 s82, s68, 1
    s_lshl_b32 s82, s82, 11
    v_xor_b32 v16, s82, v16
    v_xor_b32 v17, 32, v16
    v_xor_b32 v18, 64, v16
    v_xor_b32 v19, 96, v16
    v_xor_b32 v20, 2048, v16
    v_xor_b32 v21, 2080, v16
    v_xor_b32 v22, 2112, v16
    v_xor_b32 v23, 2144, v16
    v_add_u32 v16, s81, v16
    v_add_u32 v17, s81, v17
    v_add_u32 v18, s81, v18
    v_add_u32 v19, s81, v19
    v_add_u32 v20, s81, v20
    v_add_u32 v21, s81, v21
    v_add_u32 v22, s81, v22
    v_add_u32 v23, s81, v23
    v_add_u32 v24, s81, v1
    s_xor_b32 s82, s68, 1
    s_mul_i32 s82, s82, 40960
    v_add_u32 v25, s82, v1
    s_xor_b32 s82, s68, 2
    s_mul_i32 s82, s82, 40960
    v_add_u32 v26, s82, v1
    s_xor_b32 s82, s68, 3
    s_mul_i32 s82, s82, 40960
    v_add_u32 v27, s82, v1
    v_lshlrev_b32 v0, 3, v0
    s_waitcnt vmcnt(8)
    ds_read_b64_tr_b16 a[128:129], v8 offset:0
    s_add_u32 s82, s7, 0
    s_and_b32 s82, s82, 3
    s_lshl_b32 s82, s82, 17
    s_add_u32 s26, s82, s4
    s_add_u32 s26, s26, 128
    s_add_u32 m0, s81, 12288
    s_nop 0
    buffer_load_dwordx4 v4, s[44:47], s26 offen offset:0 lds
    ds_read_b64_tr_b16 a[130:131], v8 offset:2048
    buffer_load_dwordx4 v5, s[44:47], s26 offen offset:1024 lds
    ds_read_b64_tr_b16 a[132:133], v9 offset:0
    buffer_load_dwordx4 v6, s[44:47], s26 offen offset:2048 lds
    ds_read_b64_tr_b16 a[134:135], v9 offset:2048
    buffer_load_dwordx4 v7, s[44:47], s26 offen offset:3072 lds
    ds_read_b64_tr_b16 a[136:137], v10 offset:0
    ds_read_b64_tr_b16 a[138:139], v10 offset:2048
    ds_read_b64_tr_b16 a[140:141], v11 offset:0
    ds_read_b64_tr_b16 a[142:143], v11 offset:2048
    s_waitcnt vmcnt(8)
    ds_read_b64 a[0:1], v16 offset:4096
    s_add_u32 s82, s7, 0
    s_and_b32 s82, s82, 3
    s_lshl_b32 s82, s82, 17
    s_add_u32 s26, s82, s4
    s_add_u32 s26, s26, 65536
    s_add_u32 m0, s81, 16384
    s_nop 0
    buffer_load_dwordx4 v4, s[44:47], s26 offen offset:0 lds
    ds_read_b64 a[2:3], v17 offset:4096
    buffer_load_dwordx4 v5, s[44:47], s26 offen offset:1024 lds
    ds_read_b64 a[4:5], v20 offset:4096
    buffer_load_dwordx4 v6, s[44:47], s26 offen offset:2048 lds
    ds_read_b64 a[6:7], v21 offset:4096
    buffer_load_dwordx4 v7, s[44:47], s26 offen offset:3072 lds
    ds_read_b64 a[8:9], v18 offset:4096
    ds_read_b64 a[10:11], v19 offset:4096
    ds_read_b64 a[12:13], v22 offset:4096
    ds_read_b64 a[14:15], v23 offset:4096
    s_waitcnt vmcnt(8)
    ds_read_b64 a[16:17], v16 offset:8192
    s_add_u32 s82, s7, 0
    s_and_b32 s82, s82, 3
    s_lshl_b32 s82, s82, 17
    s_add_u32 s26, s82, s4
    s_add_u32 s26, s26, 65664
    s_add_u32 m0, s81, 20480
    s_nop 0
    buffer_load_dwordx4 v4, s[44:47], s26 offen offset:0 lds
    ds_read_b64 a[18:19], v17 offset:8192
    buffer_load_dwordx4 v5, s[44:47], s26 offen offset:1024 lds
    ds_read_b64 a[20:21], v20 offset:8192
    buffer_load_dwordx4 v6, s[44:47], s26 offen offset:2048 lds
    ds_read_b64 a[22:23], v21 offset:8192
    buffer_load_dwordx4 v7, s[44:47], s26 offen offset:3072 lds
    ds_read_b64 a[24:25], v18 offset:8192
    ds_read_b64 a[26:27], v19 offset:8192
    ds_read_b64 a[28:29], v22 offset:8192
    ds_read_b64 a[30:31], v23 offset:8192
    s_waitcnt lgkmcnt(0)
    v_mfma_f32_16x16x32_bf16 v[160:163], a[128:131], a[4:7], 0
    v_mfma_f32_16x16x32_bf16 v[164:167], a[132:135], a[4:7], 0
    v_mfma_f32_16x16x32_bf16 v[168:171], a[136:139], a[4:7], 0
    v_mfma_f32_16x16x32_bf16 v[172:175], a[140:143], a[4:7], 0
    v_mfma_f32_16x16x32_bf16 v[192:195], a[128:131], a[16:19], 0
    v_mfma_f32_16x16x32_bf16 v[196:199], a[132:135], a[16:19], 0
    v_mfma_f32_16x16x32_bf16 v[200:203], a[136:139], a[16:19], 0
    v_mfma_f32_16x16x32_bf16 v[204:207], a[140:143], a[16:19], 0
    v_mfma_f32_16x16x32_bf16 v[224:227], a[128:131], a[20:23], 0
    v_mfma_f32_16x16x32_bf16 v[228:231], a[132:135], a[20:23], 0
    s_waitcnt vmcnt(8)
    ds_read_b64_tr_b16 a[144:145], v8 offset:12288
    s_add_u32 s82, s7, 1
    s_and_b32 s82, s82, 3
    s_lshl_b32 s82, s82, 17
    s_add_u32 s26, s82, s4
    s_add_u32 m0, s81, 24576
    s_nop 0
    buffer_load_dwordx4 v4, s[44:47], s26 offen offset:0 lds
    ds_read_b64_tr_b16 a[146:147], v8 offset:14336
    v_mfma_f32_16x16x32_bf16 v[232:235], a[136:139], a[20:23], 0
    ds_read_b64_tr_b16 a[148:149], v9 offset:12288
    buffer_load_dwordx4 v5, s[44:47], s26 offen offset:1024 lds
    ds_read_b64_tr_b16 a[150:151], v9 offset:14336
    v_mfma_f32_16x16x32_bf16 v[236:239], a[140:143], a[20:23], 0
    ds_read_b64_tr_b16 a[152:153], v10 offset:12288
    buffer_load_dwordx4 v6, s[44:47], s26 offen offset:2048 lds
    ds_read_b64_tr_b16 a[154:155], v10 offset:14336
    v_mfma_f32_16x16x32_bf16 v[128:131], a[128:131], a[0:3], 0
    ds_read_b64_tr_b16 a[156:157], v11 offset:12288
    buffer_load_dwordx4 v7, s[44:47], s26 offen offset:3072 lds
    ds_read_b64_tr_b16 a[158:159], v11 offset:14336
    v_mfma_f32_16x16x32_bf16 v[132:135], a[132:135], a[0:3], 0
    v_mfma_f32_16x16x32_bf16 v[136:139], a[136:139], a[0:3], 0
    v_mfma_f32_16x16x32_bf16 v[140:143], a[140:143], a[0:3], 0
    s_waitcnt lgkmcnt(0)
    v_mfma_f32_16x16x32_bf16 v[176:179], a[144:147], a[4:7], 0
    v_mfma_f32_16x16x32_bf16 v[180:183], a[148:151], a[4:7], 0
    v_mfma_f32_16x16x32_bf16 v[184:187], a[152:155], a[4:7], 0
    v_mfma_f32_16x16x32_bf16 v[188:191], a[156:159], a[4:7], 0
    v_mfma_f32_16x16x32_bf16 v[208:211], a[144:147], a[16:19], 0
    v_mfma_f32_16x16x32_bf16 v[212:215], a[148:151], a[16:19], 0
    v_mfma_f32_16x16x32_bf16 v[216:219], a[152:155], a[16:19], 0
    v_mfma_f32_16x16x32_bf16 v[220:223], a[156:159], a[16:19], 0
    v_mfma_f32_16x16x32_bf16 v[240:243], a[144:147], a[20:23], 0
    v_mfma_f32_16x16x32_bf16 v[244:247], a[148:151], a[20:23], 0
    s_waitcnt vmcnt(8)
    ds_read_b64_tr_b16 a[160:161], v8 offset:16384
    s_add_u32 s82, s7, 1
    s_and_b32 s82, s82, 3
    s_lshl_b32 s82, s82, 7
    s_add_u32 s26, s82, s3
    s_add_u32 m0, s81, 0
    s_nop 0
    buffer_load_dwordx4 v4, s[28:31], s26 offen offset:0 lds
    ds_read_b64_tr_b16 a[162:163], v8 offset:18432
    v_mfma_f32_16x16x32_bf16 v[248:251], a[152:155], a[20:23], 0
    ds_read_b64_tr_b16 a[164:165], v9 offset:16384
    buffer_load_dwordx4 v5, s[28:31], s26 offen offset:1024 lds
    ds_read_b64_tr_b16 a[166:167], v9 offset:18432
    v_mfma_f32_16x16x32_bf16 v[252:255], a[156:159], a[20:23], 0
    ds_read_b64_tr_b16 a[168:169], v10 offset:16384
    buffer_load_dwordx4 v6, s[28:31], s26 offen offset:2048 lds
    ds_read_b64_tr_b16 a[170:171], v10 offset:18432
    v_mfma_f32_16x16x32_bf16 v[144:147], a[144:147], a[0:3], 0
    ds_read_b64_tr_b16 a[172:173], v11 offset:16384
    buffer_load_dwordx4 v7, s[28:31], s26 offen offset:3072 lds
    ds_read_b64_tr_b16 a[174:175], v11 offset:18432
    v_mfma_f32_16x16x32_bf16 v[148:151], a[148:151], a[0:3], 0
    v_mfma_f32_16x16x32_bf16 v[152:155], a[152:155], a[0:3], 0
    v_mfma_f32_16x16x32_bf16 v[156:159], a[156:159], a[0:3], 0
    s_waitcnt lgkmcnt(0)
    v_mfma_f32_16x16x32_bf16 v[160:163], a[160:163], a[12:15], v[160:163]
    v_mfma_f32_16x16x32_bf16 v[164:167], a[164:167], a[12:15], v[164:167]
    v_mfma_f32_16x16x32_bf16 v[168:171], a[168:171], a[12:15], v[168:171]
    v_mfma_f32_16x16x32_bf16 v[172:175], a[172:175], a[12:15], v[172:175]
    v_mfma_f32_16x16x32_bf16 v[192:195], a[160:163], a[24:27], v[192:195]
    v_mfma_f32_16x16x32_bf16 v[196:199], a[164:167], a[24:27], v[196:199]
    v_mfma_f32_16x16x32_bf16 v[200:203], a[168:171], a[24:27], v[200:203]
    v_mfma_f32_16x16x32_bf16 v[204:207], a[172:175], a[24:27], v[204:207]
    v_mfma_f32_16x16x32_bf16 v[224:227], a[160:163], a[28:31], v[224:227]
    v_mfma_f32_16x16x32_bf16 v[228:231], a[164:167], a[28:31], v[228:231]
    s_waitcnt vmcnt(8)
    ds_read_b64_tr_b16 a[176:177], v8 offset:20480
    s_add_u32 s82, s7, 1
    s_and_b32 s82, s82, 3
    s_lshl_b32 s82, s82, 7
    s_add_u32 s26, s82, s3
    s_xor_b32 s26, s26, 65536
    s_add_u32 m0, s81, 4096
    s_nop 0
    buffer_load_dwordx4 v4, s[28:31], s26 offen offset:0 lds
    ds_read_b64_tr_b16 a[178:179], v8 offset:22528
    v_mfma_f32_16x16x32_bf16 v[232:235], a[168:171], a[28:31], v[232:235]
    ds_read_b64_tr_b16 a[180:181], v9 offset:20480
    buffer_load_dwordx4 v5, s[28:31], s26 offen offset:1024 lds
    ds_read_b64_tr_b16 a[182:183], v9 offset:22528
    v_mfma_f32_16x16x32_bf16 v[236:239], a[172:175], a[28:31], v[236:239]
    ds_read_b64_tr_b16 a[184:185], v10 offset:20480
    buffer_load_dwordx4 v6, s[28:31], s26 offen offset:2048 lds
    ds_read_b64_tr_b16 a[186:187], v10 offset:22528
    v_mfma_f32_16x16x32_bf16 v[128:131], a[160:163], a[8:11], v[128:131]
    ds_read_b64_tr_b16 a[188:189], v11 offset:20480
    buffer_load_dwordx4 v7, s[28:31], s26 offen offset:3072 lds
    ds_read_b64_tr_b16 a[190:191], v11 offset:22528
    v_mfma_f32_16x16x32_bf16 v[132:135], a[164:167], a[8:11], v[132:135]
    v_mfma_f32_16x16x32_bf16 v[136:139], a[168:171], a[8:11], v[136:139]
    v_mfma_f32_16x16x32_bf16 v[140:143], a[172:175], a[8:11], v[140:143]
    s_waitcnt lgkmcnt(0)
    v_mfma_f32_16x16x32_bf16 v[176:179], a[176:179], a[12:15], v[176:179]
    v_mfma_f32_16x16x32_bf16 v[180:183], a[180:183], a[12:15], v[180:183]
    s_waitcnt vmcnt(8)
    ds_read_b64_tr_b16 a[192:193], v8 offset:24576
    s_add_u32 s82, s7, 1
    s_and_b32 s82, s82, 3
    s_lshl_b32 s82, s82, 17
    s_add_u32 s26, s82, s4
    s_add_u32 s26, s26, 128
    s_add_u32 m0, s81, 8192
    s_nop 0
    buffer_load_dwordx4 v4, s[44:47], s26 offen offset:0 lds
    ds_read_b64_tr_b16 a[194:195], v8 offset:26624
    v_mfma_f32_16x16x32_bf16 v[184:187], a[184:187], a[12:15], v[184:187]
    ds_read_b64_tr_b16 a[196:197], v9 offset:24576
    buffer_load_dwordx4 v5, s[44:47], s26 offen offset:1024 lds
    ds_read_b64_tr_b16 a[198:199], v9 offset:26624
    v_mfma_f32_16x16x32_bf16 v[188:191], a[188:191], a[12:15], v[188:191]
    ds_read_b64_tr_b16 a[200:201], v10 offset:24576
    buffer_load_dwordx4 v6, s[44:47], s26 offen offset:2048 lds
    ds_read_b64_tr_b16 a[202:203], v10 offset:26624
    v_mfma_f32_16x16x32_bf16 v[208:211], a[176:179], a[24:27], v[208:211]
    ds_read_b64_tr_b16 a[204:205], v11 offset:24576
    buffer_load_dwordx4 v7, s[44:47], s26 offen offset:3072 lds
    ds_read_b64_tr_b16 a[206:207], v11 offset:26624
    v_mfma_f32_16x16x32_bf16 v[212:215], a[180:183], a[24:27], v[212:215]
    s_waitcnt vmcnt(8)
    ds_read_b64 a[32:33], v16 offset:0
    s_add_u32 s82, s7, 1
    s_and_b32 s82, s82, 3
    s_lshl_b32 s82, s82, 17
    s_add_u32 s26, s82, s4
    s_add_u32 s26, s26, 65536
    s_add_u32 m0, s81, 12288
    s_nop 0
    buffer_load_dwordx4 v4, s[44:47], s26 offen offset:0 lds
    ds_read_b64 a[34:35], v17 offset:0
    v_mfma_f32_16x16x32_bf16 v[216:219], a[184:187], a[24:27], v[216:219]
    ds_read_b64 a[36:37], v20 offset:0
    buffer_load_dwordx4 v5, s[44:47], s26 offen offset:1024 lds
    ds_read_b64 a[38:39], v21 offset:0
    v_mfma_f32_16x16x32_bf16 v[220:223], a[188:191], a[24:27], v[220:223]
    ds_read_b64 a[40:41], v18 offset:0
    buffer_load_dwordx4 v6, s[44:47], s26 offen offset:2048 lds
    ds_read_b64 a[42:43], v19 offset:0
    v_mfma_f32_16x16x32_bf16 v[240:243], a[176:179], a[28:31], v[240:243]
    ds_read_b64 a[44:45], v22 offset:0
    buffer_load_dwordx4 v7, s[44:47], s26 offen offset:3072 lds
    ds_read_b64 a[46:47], v23 offset:0
    v_mfma_f32_16x16x32_bf16 v[244:247], a[180:183], a[28:31], v[244:247]
    s_waitcnt vmcnt(8)
    ds_read_b64 a[48:49], v16 offset:4096
    s_add_u32 s82, s7, 1
    s_and_b32 s82, s82, 3
    s_lshl_b32 s82, s82, 17
    s_add_u32 s26, s82, s4
    s_add_u32 s26, s26, 65664
    s_add_u32 m0, s81, 16384
    s_nop 0
    buffer_load_dwordx4 v4, s[44:47], s26 offen offset:0 lds
    ds_read_b64 a[50:51], v17 offset:4096
    v_mfma_f32_16x16x32_bf16 v[248:251], a[184:187], a[28:31], v[248:251]
    ds_read_b64 a[52:53], v20 offset:4096
    buffer_load_dwordx4 v5, s[44:47], s26 offen offset:1024 lds
    ds_read_b64 a[54:55], v21 offset:4096
    v_mfma_f32_16x16x32_bf16 v[252:255], a[188:191], a[28:31], v[252:255]
    ds_read_b64 a[56:57], v18 offset:4096
    buffer_load_dwordx4 v6, s[44:47], s26 offen offset:2048 lds
    ds_read_b64 a[58:59], v19 offset:4096
    v_mfma_f32_16x16x32_bf16 v[144:147], a[176:179], a[8:11], v[144:147]
    ds_read_b64 a[60:61], v22 offset:4096
    buffer_load_dwordx4 v7, s[44:47], s26 offen offset:3072 lds
    ds_read_b64 a[62:63], v23 offset:4096
    v_mfma_f32_16x16x32_bf16 v[148:151], a[180:183], a[8:11], v[148:151]
    v_mfma_f32_16x16x32_bf16 v[152:155], a[184:187], a[8:11], v[152:155]
    v_mfma_f32_16x16x32_bf16 v[156:159], a[188:191], a[8:11], v[156:159]
    s_waitcnt lgkmcnt(0)
    v_mfma_f32_16x16x32_bf16 v[160:163], a[192:195], a[36:39], v[160:163]
    v_mfma_f32_16x16x32_bf16 v[164:167], a[196:199], a[36:39], v[164:167]
    v_mfma_f32_16x16x32_bf16 v[168:171], a[200:203], a[36:39], v[168:171]
    v_mfma_f32_16x16x32_bf16 v[172:175], a[204:207], a[36:39], v[172:175]
    v_mfma_f32_16x16x32_bf16 v[192:195], a[192:195], a[48:51], v[192:195]
    v_mfma_f32_16x16x32_bf16 v[196:199], a[196:199], a[48:51], v[196:199]
    v_mfma_f32_16x16x32_bf16 v[200:203], a[200:203], a[48:51], v[200:203]
    v_mfma_f32_16x16x32_bf16 v[204:207], a[204:207], a[48:51], v[204:207]
    v_mfma_f32_16x16x32_bf16 v[224:227], a[192:195], a[52:55], v[224:227]
    v_mfma_f32_16x16x32_bf16 v[228:231], a[196:199], a[52:55], v[228:231]
    s_waitcnt vmcnt(8)
    ds_read_b64_tr_b16 a[208:209], v8 offset:8192
    s_add_u32 s82, s7, 2
    s_and_b32 s82, s82, 3
    s_lshl_b32 s82, s82, 17
    s_add_u32 s26, s82, s4
    s_add_u32 m0, s81, 20480
    s_nop 0
    buffer_load_dwordx4 v4, s[44:47], s26 offen offset:0 lds
    ds_read_b64_tr_b16 a[210:211], v8 offset:10240
    v_mfma_f32_16x16x32_bf16 v[232:235], a[200:203], a[52:55], v[232:235]
    ds_read_b64_tr_b16 a[212:213], v9 offset:8192
    buffer_load_dwordx4 v5, s[44:47], s26 offen offset:1024 lds
    ds_read_b64_tr_b16 a[214:215], v9 offset:10240
    v_mfma_f32_16x16x32_bf16 v[236:239], a[204:207], a[52:55], v[236:239]
    ds_read_b64_tr_b16 a[216:217], v10 offset:8192
    buffer_load_dwordx4 v6, s[44:47], s26 offen offset:2048 lds
    ds_read_b64_tr_b16 a[218:219], v10 offset:10240
    v_mfma_f32_16x16x32_bf16 v[128:131], a[192:195], a[32:35], v[128:131]
    ds_read_b64_tr_b16 a[220:221], v11 offset:8192
    buffer_load_dwordx4 v7, s[44:47], s26 offen offset:3072 lds
    ds_read_b64_tr_b16 a[222:223], v11 offset:10240
    v_mfma_f32_16x16x32_bf16 v[132:135], a[196:199], a[32:35], v[132:135]
    v_mfma_f32_16x16x32_bf16 v[136:139], a[200:203], a[32:35], v[136:139]
    v_mfma_f32_16x16x32_bf16 v[140:143], a[204:207], a[32:35], v[140:143]
    s_waitcnt lgkmcnt(0)
    v_mfma_f32_16x16x32_bf16 v[176:179], a[208:211], a[36:39], v[176:179]
    v_mfma_f32_16x16x32_bf16 v[180:183], a[212:215], a[36:39], v[180:183]
    v_mfma_f32_16x16x32_bf16 v[184:187], a[216:219], a[36:39], v[184:187]
    v_mfma_f32_16x16x32_bf16 v[188:191], a[220:223], a[36:39], v[188:191]
    v_mfma_f32_16x16x32_bf16 v[208:211], a[208:211], a[48:51], v[208:211]
    v_mfma_f32_16x16x32_bf16 v[212:215], a[212:215], a[48:51], v[212:215]
    v_mfma_f32_16x16x32_bf16 v[216:219], a[216:219], a[48:51], v[216:219]
    v_mfma_f32_16x16x32_bf16 v[220:223], a[220:223], a[48:51], v[220:223]
    v_mfma_f32_16x16x32_bf16 v[240:243], a[208:211], a[52:55], v[240:243]
    v_mfma_f32_16x16x32_bf16 v[244:247], a[212:215], a[52:55], v[244:247]
    s_waitcnt vmcnt(8)
    ds_read_b64_tr_b16 a[224:225], v8 offset:12288
    s_add_u32 s82, s7, 2
    s_and_b32 s82, s82, 3
    s_lshl_b32 s82, s82, 7
    s_add_u32 s26, s82, s3
    s_add_u32 m0, s81, 24576
    s_nop 0
    buffer_load_dwordx4 v4, s[28:31], s26 offen offset:0 lds
    ds_read_b64_tr_b16 a[226:227], v8 offset:14336
    v_mfma_f32_16x16x32_bf16 v[248:251], a[216:219], a[52:55], v[248:251]
    ds_read_b64_tr_b16 a[228:229], v9 offset:12288
    buffer_load_dwordx4 v5, s[28:31], s26 offen offset:1024 lds
    ds_read_b64_tr_b16 a[230:231], v9 offset:14336
    v_mfma_f32_16x16x32_bf16 v[252:255], a[220:223], a[52:55], v[252:255]
    ds_read_b64_tr_b16 a[232:233], v10 offset:12288
    buffer_load_dwordx4 v6, s[28:31], s26 offen offset:2048 lds
    ds_read_b64_tr_b16 a[234:235], v10 offset:14336
    v_mfma_f32_16x16x32_bf16 v[144:147], a[208:211], a[32:35], v[144:147]
    ds_read_b64_tr_b16 a[236:237], v11 offset:12288
    buffer_load_dwordx4 v7, s[28:31], s26 offen offset:3072 lds
    ds_read_b64_tr_b16 a[238:239], v11 offset:14336
    v_mfma_f32_16x16x32_bf16 v[148:151], a[212:215], a[32:35], v[148:151]
    v_mfma_f32_16x16x32_bf16 v[152:155], a[216:219], a[32:35], v[152:155]
    v_mfma_f32_16x16x32_bf16 v[156:159], a[220:223], a[32:35], v[156:159]
    s_waitcnt lgkmcnt(0)
    v_mfma_f32_16x16x32_bf16 v[160:163], a[224:227], a[44:47], v[160:163]
    v_mfma_f32_16x16x32_bf16 v[164:167], a[228:231], a[44:47], v[164:167]
    v_mfma_f32_16x16x32_bf16 v[168:171], a[232:235], a[44:47], v[168:171]
    v_mfma_f32_16x16x32_bf16 v[172:175], a[236:239], a[44:47], v[172:175]
    v_mfma_f32_16x16x32_bf16 v[192:195], a[224:227], a[56:59], v[192:195]
    v_mfma_f32_16x16x32_bf16 v[196:199], a[228:231], a[56:59], v[196:199]
    v_mfma_f32_16x16x32_bf16 v[200:203], a[232:235], a[56:59], v[200:203]
    v_mfma_f32_16x16x32_bf16 v[204:207], a[236:239], a[56:59], v[204:207]
    v_mfma_f32_16x16x32_bf16 v[224:227], a[224:227], a[60:63], v[224:227]
    v_mfma_f32_16x16x32_bf16 v[228:231], a[228:231], a[60:63], v[228:231]
    s_waitcnt vmcnt(8)
    ds_read_b64_tr_b16 a[240:241], v8 offset:16384
    s_add_u32 s82, s7, 2
    s_and_b32 s82, s82, 3
    s_lshl_b32 s82, s82, 7
    s_add_u32 s26, s82, s3
    s_xor_b32 s26, s26, 65536
    s_add_u32 m0, s81, 0
    s_nop 0
    buffer_load_dwordx4 v4, s[28:31], s26 offen offset:0 lds
    ds_read_b64_tr_b16 a[242:243], v8 offset:18432
    v_mfma_f32_16x16x32_bf16 v[232:235], a[232:235], a[60:63], v[232:235]
    ds_read_b64_tr_b16 a[244:245], v9 offset:16384
    buffer_load_dwordx4 v5, s[28:31], s26 offen offset:1024 lds
    ds_read_b64_tr_b16 a[246:247], v9 offset:18432
    v_mfma_f32_16x16x32_bf16 v[236:239], a[236:239], a[60:63], v[236:239]
    ds_read_b64_tr_b16 a[248:249], v10 offset:16384
    buffer_load_dwordx4 v6, s[28:31], s26 offen offset:2048 lds
    ds_read_b64_tr_b16 a[250:251], v10 offset:18432
    v_mfma_f32_16x16x32_bf16 v[128:131], a[224:227], a[40:43], v[128:131]
    ds_read_b64_tr_b16 a[252:253], v11 offset:16384
    buffer_load_dwordx4 v7, s[28:31], s26 offen offset:3072 lds
    ds_read_b64_tr_b16 a[254:255], v11 offset:18432
    v_mfma_f32_16x16x32_bf16 v[132:135], a[228:231], a[40:43], v[132:135]
    v_mfma_f32_16x16x32_bf16 v[136:139], a[232:235], a[40:43], v[136:139]
    v_mfma_f32_16x16x32_bf16 v[140:143], a[236:239], a[40:43], v[140:143]
    s_waitcnt lgkmcnt(0)
    v_mfma_f32_16x16x32_bf16 v[176:179], a[240:243], a[44:47], v[176:179]
    v_mfma_f32_16x16x32_bf16 v[180:183], a[244:247], a[44:47], v[180:183]
    s_waitcnt vmcnt(8)
    ds_read_b64_tr_b16 a[128:129], v8 offset:20480
    s_add_u32 s82, s7, 2
    s_and_b32 s82, s82, 3
    s_lshl_b32 s82, s82, 17
    s_add_u32 s26, s82, s4
    s_add_u32 s26, s26, 128
    s_add_u32 m0, s81, 4096
    s_nop 0
    buffer_load_dwordx4 v4, s[44:47], s26 offen offset:0 lds
    ds_read_b64_tr_b16 a[130:131], v8 offset:22528
    v_mfma_f32_16x16x32_bf16 v[184:187], a[248:251], a[44:47], v[184:187]
    ds_read_b64_tr_b16 a[132:133], v9 offset:20480
    buffer_load_dwordx4 v5, s[44:47], s26 offen offset:1024 lds
    ds_read_b64_tr_b16 a[134:135], v9 offset:22528
    v_mfma_f32_16x16x32_bf16 v[188:191], a[252:255], a[44:47], v[188:191]
    ds_read_b64_tr_b16 a[136:137], v10 offset:20480
    buffer_load_dwordx4 v6, s[44:47], s26 offen offset:2048 lds
    ds_read_b64_tr_b16 a[138:139], v10 offset:22528
    v_mfma_f32_16x16x32_bf16 v[208:211], a[240:243], a[56:59], v[208:211]
    ds_read_b64_tr_b16 a[140:141], v11 offset:20480
    buffer_load_dwordx4 v7, s[44:47], s26 offen offset:3072 lds
    ds_read_b64_tr_b16 a[142:143], v11 offset:22528
    v_mfma_f32_16x16x32_bf16 v[212:215], a[244:247], a[56:59], v[212:215]
    s_waitcnt vmcnt(8)
    ds_read_b64 a[64:65], v16 offset:24576
    s_add_u32 s82, s7, 2
    s_and_b32 s82, s82, 3
    s_lshl_b32 s82, s82, 17
    s_add_u32 s26, s82, s4
    s_add_u32 s26, s26, 65536
    s_add_u32 m0, s81, 8192
    s_nop 0
    buffer_load_dwordx4 v4, s[44:47], s26 offen offset:0 lds
    ds_read_b64 a[66:67], v17 offset:24576
    v_mfma_f32_16x16x32_bf16 v[216:219], a[248:251], a[56:59], v[216:219]
    ds_read_b64 a[68:69], v20 offset:24576
    buffer_load_dwordx4 v5, s[44:47], s26 offen offset:1024 lds
    ds_read_b64 a[70:71], v21 offset:24576
    v_mfma_f32_16x16x32_bf16 v[220:223], a[252:255], a[56:59], v[220:223]
    ds_read_b64 a[72:73], v18 offset:24576
    buffer_load_dwordx4 v6, s[44:47], s26 offen offset:2048 lds
    ds_read_b64 a[74:75], v19 offset:24576
    v_mfma_f32_16x16x32_bf16 v[240:243], a[240:243], a[60:63], v[240:243]
    ds_read_b64 a[76:77], v22 offset:24576
    buffer_load_dwordx4 v7, s[44:47], s26 offen offset:3072 lds
    ds_read_b64 a[78:79], v23 offset:24576
    v_mfma_f32_16x16x32_bf16 v[244:247], a[244:247], a[60:63], v[244:247]
    s_waitcnt vmcnt(8)
    ds_read_b64 a[80:81], v16 offset:0
    s_add_u32 s82, s7, 2
    s_and_b32 s82, s82, 3
    s_lshl_b32 s82, s82, 17
    s_add_u32 s26, s82, s4
    s_add_u32 s26, s26, 65664
    s_add_u32 m0, s81, 12288
    s_nop 0
    buffer_load_dwordx4 v4, s[44:47], s26 offen offset:0 lds
    ds_read_b64 a[82:83], v17 offset:0
    v_mfma_f32_16x16x32_bf16 v[248:251], a[248:251], a[60:63], v[248:251]
    ds_read_b64 a[84:85], v20 offset:0
    buffer_load_dwordx4 v5, s[44:47], s26 offen offset:1024 lds
    ds_read_b64 a[86:87], v21 offset:0
    v_mfma_f32_16x16x32_bf16 v[252:255], a[252:255], a[60:63], v[252:255]
    ds_read_b64 a[88:89], v18 offset:0
    buffer_load_dwordx4 v6, s[44:47], s26 offen offset:2048 lds
    ds_read_b64 a[90:91], v19 offset:0
    v_mfma_f32_16x16x32_bf16 v[144:147], a[240:243], a[40:43], v[144:147]
    ds_read_b64 a[92:93], v22 offset:0
    buffer_load_dwordx4 v7, s[44:47], s26 offen offset:3072 lds
    ds_read_b64 a[94:95], v23 offset:0
    v_mfma_f32_16x16x32_bf16 v[148:151], a[244:247], a[40:43], v[148:151]
    v_mfma_f32_16x16x32_bf16 v[152:155], a[248:251], a[40:43], v[152:155]
    v_mfma_f32_16x16x32_bf16 v[156:159], a[252:255], a[40:43], v[156:159]
    s_waitcnt lgkmcnt(0)
    v_mfma_f32_16x16x32_bf16 v[160:163], a[128:131], a[68:71], v[160:163]
    v_mfma_f32_16x16x32_bf16 v[164:167], a[132:135], a[68:71], v[164:167]
    v_mfma_f32_16x16x32_bf16 v[168:171], a[136:139], a[68:71], v[168:171]
    v_mfma_f32_16x16x32_bf16 v[172:175], a[140:143], a[68:71], v[172:175]
    v_mfma_f32_16x16x32_bf16 v[192:195], a[128:131], a[80:83], v[192:195]
    v_mfma_f32_16x16x32_bf16 v[196:199], a[132:135], a[80:83], v[196:199]
    v_mfma_f32_16x16x32_bf16 v[200:203], a[136:139], a[80:83], v[200:203]
    v_mfma_f32_16x16x32_bf16 v[204:207], a[140:143], a[80:83], v[204:207]
    v_mfma_f32_16x16x32_bf16 v[224:227], a[128:131], a[84:87], v[224:227]
    v_mfma_f32_16x16x32_bf16 v[228:231], a[132:135], a[84:87], v[228:231]
    s_waitcnt vmcnt(8)
    ds_read_b64_tr_b16 a[144:145], v8 offset:4096
    s_add_u32 s82, s7, 3
    s_and_b32 s82, s82, 3
    s_lshl_b32 s82, s82, 17
    s_add_u32 s26, s82, s4
    s_add_u32 m0, s81, 16384
    s_nop 0
    buffer_load_dwordx4 v4, s[44:47], s26 offen offset:0 lds
    ds_read_b64_tr_b16 a[146:147], v8 offset:6144
    v_mfma_f32_16x16x32_bf16 v[232:235], a[136:139], a[84:87], v[232:235]
    ds_read_b64_tr_b16 a[148:149], v9 offset:4096
    buffer_load_dwordx4 v5, s[44:47], s26 offen offset:1024 lds
    ds_read_b64_tr_b16 a[150:151], v9 offset:6144
    v_mfma_f32_16x16x32_bf16 v[236:239], a[140:143], a[84:87], v[236:239]
    ds_read_b64_tr_b16 a[152:153], v10 offset:4096
    buffer_load_dwordx4 v6, s[44:47], s26 offen offset:2048 lds
    ds_read_b64_tr_b16 a[154:155], v10 offset:6144
    v_mfma_f32_16x16x32_bf16 v[128:131], a[128:131], a[64:67], v[128:131]
    ds_read_b64_tr_b16 a[156:157], v11 offset:4096
    buffer_load_dwordx4 v7, s[44:47], s26 offen offset:3072 lds
    ds_read_b64_tr_b16 a[158:159], v11 offset:6144
    v_mfma_f32_16x16x32_bf16 v[132:135], a[132:135], a[64:67], v[132:135]
    v_mfma_f32_16x16x32_bf16 v[136:139], a[136:139], a[64:67], v[136:139]
    v_mfma_f32_16x16x32_bf16 v[140:143], a[140:143], a[64:67], v[140:143]
    s_waitcnt lgkmcnt(0)
    v_mfma_f32_16x16x32_bf16 v[176:179], a[144:147], a[68:71], v[176:179]
    v_mfma_f32_16x16x32_bf16 v[180:183], a[148:151], a[68:71], v[180:183]
    v_mfma_f32_16x16x32_bf16 v[184:187], a[152:155], a[68:71], v[184:187]
    v_mfma_f32_16x16x32_bf16 v[188:191], a[156:159], a[68:71], v[188:191]
    v_mfma_f32_16x16x32_bf16 v[208:211], a[144:147], a[80:83], v[208:211]
    v_mfma_f32_16x16x32_bf16 v[212:215], a[148:151], a[80:83], v[212:215]
    v_mfma_f32_16x16x32_bf16 v[216:219], a[152:155], a[80:83], v[216:219]
    v_mfma_f32_16x16x32_bf16 v[220:223], a[156:159], a[80:83], v[220:223]
    v_mfma_f32_16x16x32_bf16 v[240:243], a[144:147], a[84:87], v[240:243]
    v_mfma_f32_16x16x32_bf16 v[244:247], a[148:151], a[84:87], v[244:247]
    s_waitcnt vmcnt(8)
    ds_read_b64_tr_b16 a[160:161], v8 offset:8192
    s_add_u32 s82, s7, 3
    s_and_b32 s82, s82, 3
    s_lshl_b32 s82, s82, 7
    s_add_u32 s26, s82, s3
    s_add_u32 m0, s81, 20480
    s_nop 0
    buffer_load_dwordx4 v4, s[28:31], s26 offen offset:0 lds
    ds_read_b64_tr_b16 a[162:163], v8 offset:10240
    v_mfma_f32_16x16x32_bf16 v[248:251], a[152:155], a[84:87], v[248:251]
    ds_read_b64_tr_b16 a[164:165], v9 offset:8192
    buffer_load_dwordx4 v5, s[28:31], s26 offen offset:1024 lds
    ds_read_b64_tr_b16 a[166:167], v9 offset:10240
    v_mfma_f32_16x16x32_bf16 v[252:255], a[156:159], a[84:87], v[252:255]
    ds_read_b64_tr_b16 a[168:169], v10 offset:8192
    buffer_load_dwordx4 v6, s[28:31], s26 offen offset:2048 lds
    ds_read_b64_tr_b16 a[170:171], v10 offset:10240
    v_mfma_f32_16x16x32_bf16 v[144:147], a[144:147], a[64:67], v[144:147]
    ds_read_b64_tr_b16 a[172:173], v11 offset:8192
    buffer_load_dwordx4 v7, s[28:31], s26 offen offset:3072 lds
    ds_read_b64_tr_b16 a[174:175], v11 offset:10240
    v_mfma_f32_16x16x32_bf16 v[148:151], a[148:151], a[64:67], v[148:151]
    v_mfma_f32_16x16x32_bf16 v[152:155], a[152:155], a[64:67], v[152:155]
    v_mfma_f32_16x16x32_bf16 v[156:159], a[156:159], a[64:67], v[156:159]
    s_waitcnt lgkmcnt(0)
    v_mfma_f32_16x16x32_bf16 v[160:163], a[160:163], a[76:79], v[160:163]
    v_mfma_f32_16x16x32_bf16 v[164:167], a[164:167], a[76:79], v[164:167]
    v_mfma_f32_16x16x32_bf16 v[168:171], a[168:171], a[76:79], v[168:171]
    v_mfma_f32_16x16x32_bf16 v[172:175], a[172:175], a[76:79], v[172:175]
    v_mfma_f32_16x16x32_bf16 v[192:195], a[160:163], a[88:91], v[192:195]
    v_mfma_f32_16x16x32_bf16 v[196:199], a[164:167], a[88:91], v[196:199]
    v_mfma_f32_16x16x32_bf16 v[200:203], a[168:171], a[88:91], v[200:203]
    v_mfma_f32_16x16x32_bf16 v[204:207], a[172:175], a[88:91], v[204:207]
    v_mfma_f32_16x16x32_bf16 v[224:227], a[160:163], a[92:95], v[224:227]
    v_mfma_f32_16x16x32_bf16 v[228:231], a[164:167], a[92:95], v[228:231]
    s_waitcnt vmcnt(8)
    ds_read_b64_tr_b16 a[176:177], v8 offset:12288
    s_add_u32 s82, s7, 3
    s_and_b32 s82, s82, 3
    s_lshl_b32 s82, s82, 7
    s_add_u32 s26, s82, s3
    s_xor_b32 s26, s26, 65536
    s_add_u32 m0, s81, 24576
    s_nop 0
    buffer_load_dwordx4 v4, s[28:31], s26 offen offset:0 lds
    ds_read_b64_tr_b16 a[178:179], v8 offset:14336
    v_mfma_f32_16x16x32_bf16 v[232:235], a[168:171], a[92:95], v[232:235]
    ds_read_b64_tr_b16 a[180:181], v9 offset:12288
    buffer_load_dwordx4 v5, s[28:31], s26 offen offset:1024 lds
    ds_read_b64_tr_b16 a[182:183], v9 offset:14336
    v_mfma_f32_16x16x32_bf16 v[236:239], a[172:175], a[92:95], v[236:239]
    ds_read_b64_tr_b16 a[184:185], v10 offset:12288
    buffer_load_dwordx4 v6, s[28:31], s26 offen offset:2048 lds
    ds_read_b64_tr_b16 a[186:187], v10 offset:14336
    v_mfma_f32_16x16x32_bf16 v[128:131], a[160:163], a[72:75], v[128:131]
    ds_read_b64_tr_b16 a[188:189], v11 offset:12288
    buffer_load_dwordx4 v7, s[28:31], s26 offen offset:3072 lds
    ds_read_b64_tr_b16 a[190:191], v11 offset:14336
    v_mfma_f32_16x16x32_bf16 v[132:135], a[164:167], a[72:75], v[132:135]
    v_mfma_f32_16x16x32_bf16 v[136:139], a[168:171], a[72:75], v[136:139]
    v_mfma_f32_16x16x32_bf16 v[140:143], a[172:175], a[72:75], v[140:143]
    s_waitcnt lgkmcnt(0)
    v_mfma_f32_16x16x32_bf16 v[176:179], a[176:179], a[76:79], v[176:179]
    v_mfma_f32_16x16x32_bf16 v[180:183], a[180:183], a[76:79], v[180:183]
    s_waitcnt vmcnt(8)
    ds_read_b64_tr_b16 a[192:193], v8 offset:16384
    buffer_load_dwordx2 v[2:3], off, s[60:63], 0 sc1
    ds_read_b64_tr_b16 a[194:195], v8 offset:18432
    v_mfma_f32_16x16x32_bf16 v[184:187], a[184:187], a[76:79], v[184:187]
    ds_read_b64_tr_b16 a[196:197], v9 offset:16384
    s_add_u32 s82, s7, 3
    s_and_b32 s82, s82, 3
    s_lshl_b32 s82, s82, 17
    s_add_u32 s26, s82, s4
    s_add_u32 s26, s26, 65536
    s_add_u32 m0, s81, 0
    s_nop 0
    buffer_load_dwordx4 v4, s[44:47], s26 offen offset:0 lds
    ds_read_b64_tr_b16 a[198:199], v9 offset:18432
    v_mfma_f32_16x16x32_bf16 v[188:191], a[188:191], a[76:79], v[188:191]
    ds_read_b64_tr_b16 a[200:201], v10 offset:16384
    buffer_load_dwordx4 v5, s[44:47], s26 offen offset:1024 lds
    ds_read_b64_tr_b16 a[202:203], v10 offset:18432
    v_mfma_f32_16x16x32_bf16 v[208:211], a[176:179], a[88:91], v[208:211]
    ds_read_b64_tr_b16 a[204:205], v11 offset:16384
    buffer_load_dwordx4 v6, s[44:47], s26 offen offset:2048 lds
    ds_read_b64_tr_b16 a[206:207], v11 offset:18432
    v_mfma_f32_16x16x32_bf16 v[212:215], a[180:183], a[88:91], v[212:215]
    s_waitcnt vmcnt(8)
    ds_read_b64 a[96:97], v16 offset:20480
    buffer_load_dwordx4 v7, s[44:47], s26 offen offset:3072 lds
    ds_read_b64 a[98:99], v17 offset:20480
    v_mfma_f32_16x16x32_bf16 v[216:219], a[184:187], a[88:91], v[216:219]
    ds_read_b64 a[100:101], v20 offset:20480
    s_add_u32 s82, s7, 3
    s_and_b32 s82, s82, 3
    s_lshl_b32 s82, s82, 17
    s_add_u32 s26, s82, s4
    s_add_u32 s26, s26, 128
    s_add_u32 m0, s81, 4096
    s_nop 0
    buffer_load_dwordx4 v4, s[44:47], s26 offen offset:0 lds
    ds_read_b64 a[102:103], v21 offset:20480
    v_mfma_f32_16x16x32_bf16 v[220:223], a[188:191], a[88:91], v[220:223]
    ds_read_b64 a[104:105], v18 offset:20480
    buffer_load_dwordx4 v5, s[44:47], s26 offen offset:1024 lds
    ds_read_b64 a[106:107], v19 offset:20480
    v_mfma_f32_16x16x32_bf16 v[240:243], a[176:179], a[92:95], v[240:243]
    ds_read_b64 a[108:109], v22 offset:20480
    buffer_load_dwordx4 v6, s[44:47], s26 offen offset:2048 lds
    ds_read_b64 a[110:111], v23 offset:20480
    v_mfma_f32_16x16x32_bf16 v[244:247], a[180:183], a[92:95], v[244:247]
    s_waitcnt vmcnt(8)
    ds_read_b64 a[112:113], v16 offset:24576
    buffer_load_dwordx4 v7, s[44:47], s26 offen offset:3072 lds
    ds_read_b64 a[114:115], v17 offset:24576
    v_mfma_f32_16x16x32_bf16 v[248:251], a[184:187], a[92:95], v[248:251]
    ds_read_b64 a[116:117], v20 offset:24576
    s_add_u32 s82, s7, 3
    s_and_b32 s82, s82, 3
    s_lshl_b32 s82, s82, 17
    s_add_u32 s26, s82, s4
    s_add_u32 s26, s26, 65664
    s_add_u32 m0, s81, 8192
    s_nop 0
    buffer_load_dwordx4 v4, s[44:47], s26 offen offset:0 lds
    ds_read_b64 a[118:119], v21 offset:24576
    v_mfma_f32_16x16x32_bf16 v[252:255], a[188:191], a[92:95], v[252:255]
    ds_read_b64 a[120:121], v18 offset:24576
    buffer_load_dwordx4 v5, s[44:47], s26 offen offset:1024 lds
    ds_read_b64 a[122:123], v19 offset:24576
    v_mfma_f32_16x16x32_bf16 v[144:147], a[176:179], a[72:75], v[144:147]
    ds_read_b64 a[124:125], v22 offset:24576
    buffer_load_dwordx4 v6, s[44:47], s26 offen offset:2048 lds
    ds_read_b64 a[126:127], v23 offset:24576
    v_mfma_f32_16x16x32_bf16 v[148:151], a[180:183], a[72:75], v[148:151]
    v_mfma_f32_16x16x32_bf16 v[152:155], a[184:187], a[72:75], v[152:155]
    v_mfma_f32_16x16x32_bf16 v[156:159], a[188:191], a[72:75], v[156:159]
    s_waitcnt lgkmcnt(0)
    v_mfma_f32_16x16x32_bf16 v[160:163], a[192:195], a[100:103], v[160:163]
    v_mfma_f32_16x16x32_bf16 v[164:167], a[196:199], a[100:103], v[164:167]
    v_mfma_f32_16x16x32_bf16 v[168:171], a[200:203], a[100:103], v[168:171]
    v_mfma_f32_16x16x32_bf16 v[172:175], a[204:207], a[100:103], v[172:175]
    v_mfma_f32_16x16x32_bf16 v[192:195], a[192:195], a[112:115], v[192:195]
    v_mfma_f32_16x16x32_bf16 v[196:199], a[196:199], a[112:115], v[196:199]
    v_mfma_f32_16x16x32_bf16 v[200:203], a[200:203], a[112:115], v[200:203]
    v_mfma_f32_16x16x32_bf16 v[204:207], a[204:207], a[112:115], v[204:207]
    v_mfma_f32_16x16x32_bf16 v[224:227], a[192:195], a[116:119], v[224:227]
    v_mfma_f32_16x16x32_bf16 v[228:231], a[196:199], a[116:119], v[228:231]
    s_waitcnt vmcnt(7)
    ds_read_b64_tr_b16 a[208:209], v8 offset:0
    buffer_load_dwordx4 v7, s[44:47], s26 offen offset:3072 lds
    ds_read_b64_tr_b16 a[210:211], v8 offset:2048
    v_mfma_f32_16x16x32_bf16 v[232:235], a[200:203], a[116:119], v[232:235]
    ds_read_b64_tr_b16 a[212:213], v9 offset:0
    s_mov_b32 s85, 30000
tokl_1001:
    v_readfirstlane_b32 s72, v2
    v_readfirstlane_b32 s73, v3
    s_cmp_lg_u64 s[72:73], 0
    s_cbranch_scc1 toko_1002
    s_sub_u32 s85, s85, 1
    s_cbranch_scc1 toko_1002
    buffer_load_dwordx2 v[2:3], off, s[60:63], 0 sc1
    s_waitcnt vmcnt(0)
    s_branch tokl_1001
toko_1002:
    ds_read_b64_tr_b16 a[214:215], v9 offset:2048
    v_mfma_f32_16x16x32_bf16 v[236:239], a[204:207], a[116:119], v[236:239]
    ds_read_b64_tr_b16 a[216:217], v10 offset:0
    s_lshr_b32 s82, s5, 1
    s_lshl2_add_u32 s82, s69, s82
    s_lshl_b32 s82, s82, 7
    s_and_b32 s83, s5, 1
    s_lshl2_add_u32 s83, s83, s68
    s_lshl3_add_u32 s82, s83, s82
    s_add_u32 s82, s82, 3145728
    v_mov_b32 v28, s72
    v_mov_b32 v29, s73
    s_mov_b64 exec, 1
    buffer_store_dwordx2 v[28:29], off, s[56:59], s82 sc1
    s_mov_b64 exec, -1
    ds_read_b64_tr_b16 a[218:219], v10 offset:2048
    v_mfma_f32_16x16x32_bf16 v[128:131], a[192:195], a[96:99], v[128:131]
    ds_read_b64_tr_b16 a[220:221], v11 offset:0
    ds_read_b64_tr_b16 a[222:223], v11 offset:2048
    v_mfma_f32_16x16x32_bf16 v[132:135], a[196:199], a[96:99], v[132:135]
    v_mfma_f32_16x16x32_bf16 v[136:139], a[200:203], a[96:99], v[136:139]
    v_mfma_f32_16x16x32_bf16 v[140:143], a[204:207], a[96:99], v[140:143]
    s_waitcnt lgkmcnt(0)
    v_mfma_f32_16x16x32_bf16 v[160:163], a[208:211], a[108:111], v[160:163]
    v_mfma_f32_16x16x32_bf16 v[164:167], a[212:215], a[108:111], v[164:167]
    v_mfma_f32_16x16x32_bf16 v[168:171], a[216:219], a[108:111], v[168:171]
    v_mfma_f32_16x16x32_bf16 v[172:175], a[220:223], a[108:111], v[172:175]
    v_mfma_f32_16x16x32_bf16 v[192:195], a[208:211], a[120:123], v[192:195]
    ds_write_b128 v24, v[160:163] offset:28672
    v_mfma_f32_16x16x32_bf16 v[196:199], a[212:215], a[120:123], v[196:199]
    ds_write_b128 v24, v[164:167] offset:29696
    v_mfma_f32_16x16x32_bf16 v[200:203], a[216:219], a[120:123], v[200:203]
    ds_write_b128 v24, v[168:171] offset:30720
    v_mfma_f32_16x16x32_bf16 v[204:207], a[220:223], a[120:123], v[204:207]
    ds_write_b128 v24, v[172:175] offset:31744
    v_mfma_f32_16x16x32_bf16 v[224:227], a[208:211], a[124:127], v[224:227]
    ds_write_b128 v24, v[192:195] offset:32768
    v_mfma_f32_16x16x32_bf16 v[228:231], a[212:215], a[124:127], v[228:231]
    ds_write_b128 v24, v[196:199] offset:33792
    s_waitcnt vmcnt(5)
    ds_read_b64_tr_b16 a[224:225], v8 offset:4096
    ds_read_b64_tr_b16 a[226:227], v8 offset:6144
    v_mfma_f32_16x16x32_bf16 v[232:235], a[216:219], a[124:127], v[232:235]
    ds_write_b128 v24, v[200:203] offset:34816
    ds_read_b64_tr_b16 a[228:229], v9 offset:4096
    ds_read_b64_tr_b16 a[230:231], v9 offset:6144
    v_mfma_f32_16x16x32_bf16 v[236:239], a[220:223], a[124:127], v[236:239]
    ds_write_b128 v24, v[204:207] offset:35840
    ds_read_b64_tr_b16 a[232:233], v10 offset:4096
    ds_read_b64_tr_b16 a[234:235], v10 offset:6144
    v_mfma_f32_16x16x32_bf16 v[128:131], a[208:211], a[104:107], v[128:131]
    ds_write_b128 v24, v[224:227] offset:36864
    ds_read_b64_tr_b16 a[236:237], v11 offset:4096
    ds_read_b64_tr_b16 a[238:239], v11 offset:6144
    v_mfma_f32_16x16x32_bf16 v[132:135], a[212:215], a[104:107], v[132:135]
    ds_write_b128 v24, v[228:231] offset:37888
    v_mfma_f32_16x16x32_bf16 v[136:139], a[216:219], a[104:107], v[136:139]
    ds_write_b128 v24, v[232:235] offset:38912
    v_mfma_f32_16x16x32_bf16 v[140:143], a[220:223], a[104:107], v[140:143]
    ds_write_b128 v24, v[236:239] offset:39936
    s_waitcnt lgkmcnt(3)
    v_mfma_f32_16x16x32_bf16 v[176:179], a[224:227], a[100:103], v[176:179]
    v_mfma_f32_16x16x32_bf16 v[180:183], a[228:231], a[100:103], v[180:183]
    v_mfma_f32_16x16x32_bf16 v[184:187], a[232:235], a[100:103], v[184:187]
    s_waitcnt lgkmcnt(0)
    s_barrier
    v_mfma_f32_16x16x32_bf16 v[188:191], a[236:239], a[100:103], v[188:191]
    ds_read_b128 v[32:35], v25 offset:28672
    ds_read_b128 v[36:39], v25 offset:29696
    v_mfma_f32_16x16x32_bf16 v[208:211], a[224:227], a[112:115], v[208:211]
    ds_read_b128 v[40:43], v25 offset:30720
    ds_read_b128 v[44:47], v25 offset:31744
    v_mfma_f32_16x16x32_bf16 v[212:215], a[228:231], a[112:115], v[212:215]
    ds_read_b128 v[48:51], v26 offset:32768
    ds_read_b128 v[52:55], v26 offset:33792
    v_mfma_f32_16x16x32_bf16 v[216:219], a[232:235], a[112:115], v[216:219]
    ds_read_b128 v[56:59], v26 offset:34816
    ds_read_b128 v[60:63], v26 offset:35840
    v_mfma_f32_16x16x32_bf16 v[220:223], a[236:239], a[112:115], v[220:223]
    ds_read_b128 v[64:67], v27 offset:36864
    ds_read_b128 v[68:71], v27 offset:37888
    v_mfma_f32_16x16x32_bf16 v[240:243], a[224:227], a[116:119], v[240:243]
    ds_read_b128 v[72:75], v27 offset:38912
    ds_read_b128 v[76:79], v27 offset:39936
    v_mfma_f32_16x16x32_bf16 v[244:247], a[228:231], a[116:119], v[244:247]
    s_waitcnt vmcnt(1)
    ds_read_b64_tr_b16 a[240:241], v8 offset:8192
    ds_read_b64_tr_b16 a[242:243], v8 offset:10240
    v_mfma_f32_16x16x32_bf16 v[248:251], a[232:235], a[116:119], v[248:251]
    ds_read_b64_tr_b16 a[244:245], v9 offset:8192
    ds_read_b64_tr_b16 a[246:247], v9 offset:10240
    v_mfma_f32_16x16x32_bf16 v[252:255], a[236:239], a[116:119], v[252:255]
    ds_read_b64_tr_b16 a[248:249], v10 offset:8192
    ds_read_b64_tr_b16 a[250:251], v10 offset:10240
    v_mfma_f32_16x16x32_bf16 v[144:147], a[224:227], a[96:99], v[144:147]
    ds_read_b64_tr_b16 a[252:253], v11 offset:8192
    ds_read_b64_tr_b16 a[254:255], v11 offset:10240
    v_mfma_f32_16x16x32_bf16 v[148:151], a[228:231], a[96:99], v[148:151]
    s_waitcnt lgkmcnt(15)
    v_add_f32 v32, v32, v128
    v_add_f32 v33, v33, v129
    v_mfma_f32_16x16x32_bf16 v[152:155], a[232:235], a[96:99], v[152:155]
    v_add_f32 v34, v34, v130
    v_add_f32 v35, v35, v131
    v_mfma_f32_16x16x32_bf16 v[156:159], a[236:239], a[96:99], v[156:159]
    v_add_f32 v36, v36, v132
    v_add_f32 v37, v37, v133
    s_waitcnt lgkmcnt(0)
    v_mfma_f32_16x16x32_bf16 v[176:179], a[240:243], a[108:111], v[176:179]
    v_add_f32 v38, v38, v134
    v_add_f32 v39, v39, v135
    v_mfma_f32_16x16x32_bf16 v[180:183], a[244:247], a[108:111], v[180:183]
    v_add_f32 v40, v40, v136
    v_add_f32 v41, v41, v137
    v_mfma_f32_16x16x32_bf16 v[184:187], a[248:251], a[108:111], v[184:187]
    v_add_f32 v42, v42, v138
    v_add_f32 v43, v43, v139
    v_mfma_f32_16x16x32_bf16 v[188:191], a[252:255], a[108:111], v[188:191]
    v_add_f32 v44, v44, v140
    v_add_f32 v45, v45, v141
    v_mfma_f32_16x16x32_bf16 v[208:211], a[240:243], a[120:123], v[208:211]
    ds_write_b128 v24, v[176:179] offset:0
    v_add_f32 v46, v46, v142
    v_add_f32 v47, v47, v143
    v_mfma_f32_16x16x32_bf16 v[212:215], a[244:247], a[120:123], v[212:215]
    ds_write_b128 v24, v[180:183] offset:1024
    v_add_f32 v48, v48, v64
    v_add_f32 v49, v49, v65
    v_mfma_f32_16x16x32_bf16 v[216:219], a[248:251], a[120:123], v[216:219]
    ds_write_b128 v24, v[184:187] offset:2048
    v_add_f32 v50, v50, v66
    v_add_f32 v51, v51, v67
    v_mfma_f32_16x16x32_bf16 v[220:223], a[252:255], a[120:123], v[220:223]
    ds_write_b128 v24, v[188:191] offset:3072
    v_add_f32 v52, v52, v68
    v_add_f32 v53, v53, v69
    v_mfma_f32_16x16x32_bf16 v[240:243], a[240:243], a[124:127], v[240:243]
    ds_write_b128 v24, v[208:211] offset:4096
    v_add_f32 v54, v54, v70
    v_add_f32 v55, v55, v71
    v_mfma_f32_16x16x32_bf16 v[244:247], a[244:247], a[124:127], v[244:247]
    ds_write_b128 v24, v[212:215] offset:5120
    v_add_f32 v32, v32, v48
    v_add_f32 v33, v33, v49
    v_mfma_f32_16x16x32_bf16 v[248:251], a[248:251], a[124:127], v[248:251]
    ds_write_b128 v24, v[216:219] offset:6144
    v_add_f32 v34, v34, v50
    v_add_f32 v35, v35, v51
    v_mfma_f32_16x16x32_bf16 v[252:255], a[252:255], a[124:127], v[252:255]
    ds_write_b128 v24, v[220:223] offset:7168
    v_add_f32 v36, v36, v52
    v_add_f32 v37, v37, v53
    v_mfma_f32_16x16x32_bf16 v[144:147], a[240:243], a[104:107], v[144:147]
    ds_write_b128 v24, v[240:243] offset:8192
    v_add_f32 v38, v38, v54
    v_add_f32 v39, v39, v55
    v_mfma_f32_16x16x32_bf16 v[148:151], a[244:247], a[104:107], v[148:151]
    ds_write_b128 v24, v[244:247] offset:9216
    v_cvt_pk_bf16_f32 v48, v32, v33
    v_mfma_f32_16x16x32_bf16 v[152:155], a[248:251], a[104:107], v[152:155]
    ds_write_b128 v24, v[248:251] offset:10240
    v_cvt_pk_bf16_f32 v49, v34, v35
    v_mfma_f32_16x16x32_bf16 v[156:159], a[252:255], a[104:107], v[156:159]
    ds_write_b128 v24, v[252:255] offset:11264
    s_waitcnt lgkmcnt(0)
    s_barrier
    ds_read_b128 v[80:83], v25 offset:0
    ds_read_b128 v[84:87], v25 offset:1024
    ds_read_b128 v[88:91], v25 offset:2048
    ds_read_b128 v[92:95], v25 offset:3072
    ds_read_b128 v[96:99], v26 offset:4096
    ds_read_b128 v[100:103], v26 offset:5120
    ds_read_b128 v[104:107], v26 offset:6144
    ds_read_b128 v[108:111], v26 offset:7168
    ds_read_b128 v[112:115], v27 offset:8192
    ds_read_b128 v[116:119], v27 offset:9216
    ds_read_b128 v[120:123], v27 offset:10240
    ds_read_b128 v[124:127], v27 offset:11264
    v_cvt_pk_bf16_f32 v50, v36, v37
    v_cvt_pk_bf16_f32 v51, v38, v39
    v_min_u32 v48, -2, v48
    buffer_store_dwordx4 v[48:51], v1, s[56:59], s6 offen offset:0 sc1
    v_pk_add_f32 v[56:57], v[56:57], v[72:73]
    v_pk_add_f32 v[58:59], v[58:59], v[74:75]
    v_pk_add_f32 v[60:61], v[60:61], v[76:77]
    v_pk_add_f32 v[62:63], v[62:63], v[78:79]
    v_pk_add_f32 v[40:41], v[40:41], v[56:57]
    v_pk_add_f32 v[42:43], v[42:43], v[58:59]
    v_pk_add_f32 v[44:45], v[44:45], v[60:61]
    v_pk_add_f32 v[46:47], v[46:47], v[62:63]
    v_cvt_pk_bf16_f32 v56, v40, v41
    v_cvt_pk_bf16_f32 v57, v42, v43
    v_cvt_pk_bf16_f32 v58, v44, v45
    v_cvt_pk_bf16_f32 v59, v46, v47
    v_min_u32 v56, -2, v56
    buffer_store_dwordx4 v[56:59], v1, s[56:59], s6 offen offset:1024 sc1
    s_waitcnt lgkmcnt(8)
    v_pk_add_f32 v[80:81], v[80:81], v[144:145]
    v_pk_add_f32 v[82:83], v[82:83], v[146:147]
    v_pk_add_f32 v[84:85], v[84:85], v[148:149]
    v_pk_add_f32 v[86:87], v[86:87], v[150:151]
    v_pk_add_f32 v[88:89], v[88:89], v[152:153]
    v_pk_add_f32 v[90:91], v[90:91], v[154:155]
    v_pk_add_f32 v[92:93], v[92:93], v[156:157]
    v_pk_add_f32 v[94:95], v[94:95], v[158:159]
    s_waitcnt lgkmcnt(0)
    v_pk_add_f32 v[96:97], v[96:97], v[112:113]
    v_pk_add_f32 v[98:99], v[98:99], v[114:115]
    v_pk_add_f32 v[100:101], v[100:101], v[116:117]
    v_pk_add_f32 v[102:103], v[102:103], v[118:119]
    v_pk_add_f32 v[80:81], v[80:81], v[96:97]
    v_pk_add_f32 v[82:83], v[82:83], v[98:99]
    v_pk_add_f32 v[84:85], v[84:85], v[100:101]
    v_pk_add_f32 v[86:87], v[86:87], v[102:103]
    v_cvt_pk_bf16_f32 v96, v80, v81
    v_cvt_pk_bf16_f32 v97, v82, v83
    v_cvt_pk_bf16_f32 v98, v84, v85
    v_cvt_pk_bf16_f32 v99, v86, v87
    v_min_u32 v96, -2, v96
    buffer_store_dwordx4 v[96:99], v1, s[56:59], s6 offen offset:2048 sc1
    v_pk_add_f32 v[104:105], v[104:105], v[120:121]
    v_pk_add_f32 v[106:107], v[106:107], v[122:123]
    v_pk_add_f32 v[108:109], v[108:109], v[124:125]
    v_pk_add_f32 v[110:111], v[110:111], v[126:127]
    v_pk_add_f32 v[88:89], v[88:89], v[104:105]
    v_pk_add_f32 v[90:91], v[90:91], v[106:107]
    v_pk_add_f32 v[92:93], v[92:93], v[108:109]
    v_pk_add_f32 v[94:95], v[94:95], v[110:111]
    v_cvt_pk_bf16_f32 v104, v88, v89
    v_cvt_pk_bf16_f32 v105, v90, v91
    v_cvt_pk_bf16_f32 v106, v92, v93
    v_cvt_pk_bf16_f32 v107, v94, v95
    v_min_u32 v104, -2, v104
    buffer_store_dwordx4 v[104:107], v1, s[56:59], s6 offen offset:3072 sc1
    v_bfe_u32 v4, v1, 4, 3
    v_bfe_u32 v5, v1, 7, 2
    v_lshl_add_u32 v4, v5, 4, v4
    v_mul_u32_u24 v4, 7168, v4
    v_lshrrev_b32 v5, 9, v1
    v_lshl_add_u32 v4, v5, 7, v4
    s_and_b32 s3, s2, 1
    s_bfe_u32 s4, s2, 0x20001
    s_lshl1_add_u32 s5, s3, 1
    s_lshl2_add_u32 s5, s7, s5
    s_mul_i32 s3, s3, 14
    s_lshl2_add_u32 s4, s4, s68
    s_mul_i32 s4, s4, 7
    s_xor_b32 s6, s5, 0
    s_cmp_ge_u32 s6, 14
    s_cbranch_scc1 sp_1003
    s_lshr_b32 s82, s6, 1
    s_add_u32 s82, s82, 4
    s_sub_u32 s83, s82, 7
    s_cselect_b32 s82, s82, s83
    s_add_u32 s82, s82, s4
    s_lshr_b32 s83, s82, 1
    s_and_b32 s82, s82, 1
    s_lshl3_add_u32 s82, s83, s82
    s_mul_i32 s82, s82, 57344
    s_add_u32 s6, s6, s3
    s_lshl_b32 s6, s6, 8
    s_add_u32 s82, s82, s6
    s_mov_b32 exec_lo, -1
    buffer_load_dword v8, v4, s[48:51], s82 offen
sp_1003:
    s_xor_b32 s6, s5, 0
    s_cmp_ge_u32 s6, 14
    s_cbranch_scc1 sp_1004
    s_lshr_b32 s82, s6, 1
    s_add_u32 s82, s82, 5
    s_sub_u32 s83, s82, 7
    s_cselect_b32 s82, s82, s83
    s_add_u32 s82, s82, s4
    s_lshr_b32 s83, s82, 1
    s_and_b32 s82, s82, 1
    s_lshl3_add_u32 s82, s83, s82
    s_mul_i32 s82, s82, 57344
    s_add_u32 s6, s6, s3
    s_lshl_b32 s6, s6, 8
    s_add_u32 s82, s82, s6
    s_mov_b32 exec_lo, -1
    buffer_load_dword v9, v4, s[48:51], s82 offen
sp_1004:
    s_xor_b32 s6, s5, 0
    s_cmp_ge_u32 s6, 14
    s_cbranch_scc1 sp_1005
    s_lshr_b32 s82, s6, 1
    s_add_u32 s82, s82, 6
    s_sub_u32 s83, s82, 7
    s_cselect_b32 s82, s82, s83
    s_add_u32 s82, s82, s4
    s_lshr_b32 s83, s82, 1
    s_and_b32 s82, s82, 1
    s_lshl3_add_u32 s82, s83, s82
    s_mul_i32 s82, s82, 57344
    s_add_u32 s6, s6, s3
    s_lshl_b32 s6, s6, 8
    s_add_u32 s82, s82, s6
    s_mov_b32 exec_lo, -1
    buffer_load_dword v10, v4, s[48:51], s82 offen
sp_1005:
    s_xor_b32 s6, s5, 1
    s_cmp_ge_u32 s6, 14
    s_cbranch_scc1 sp_1006
    s_lshr_b32 s82, s6, 1
    s_add_u32 s82, s82, 6
    s_sub_u32 s83, s82, 7
    s_cselect_b32 s82, s82, s83
    s_add_u32 s82, s82, s4
    s_lshr_b32 s83, s82, 1
    s_and_b32 s82, s82, 1
    s_lshl3_add_u32 s82, s83, s82
    s_mul_i32 s82, s82, 57344
    s_add_u32 s6, s6, s3
    s_lshl_b32 s6, s6, 8
    s_add_u32 s82, s82, s6
    s_mov_b32 exec_lo, -1
    buffer_load_dword v11, v4, s[48:51], s82 offen
sp_1006:
    s_xor_b32 s6, s5, 2
    s_cmp_ge_u32 s6, 14
    s_cbranch_scc1 sp_1007
    s_lshr_b32 s82, s6, 1
    s_add_u32 s82, s82, 6
    s_sub_u32 s83, s82, 7
    s_cselect_b32 s82, s82, s83
    s_add_u32 s82, s82, s4
    s_lshr_b32 s83, s82, 1
    s_and_b32 s82, s82, 1
    s_lshl3_add_u32 s82, s83, s82
    s_mul_i32 s82, s82, 57344
    s_add_u32 s6, s6, s3
    s_lshl_b32 s6, s6, 8
    s_add_u32 s82, s82, s6
    s_mov_b32 exec_lo, -1
    buffer_load_dword v12, v4, s[48:51], s82 offen
sp_1007:
    s_xor_b32 s6, s5, 3
    s_cmp_ge_u32 s6, 14
    s_cbranch_scc1 sp_1008
    s_lshr_b32 s82, s6, 1
    s_add_u32 s82, s82, 6
    s_sub_u32 s83, s82, 7
    s_cselect_b32 s82, s82, s83
    s_add_u32 s82, s82, s4
    s_lshr_b32 s83, s82, 1
    s_and_b32 s82, s82, 1
    s_lshl3_add_u32 s82, s83, s82
    s_mul_i32 s82, s82, 57344
    s_add_u32 s6, s6, s3
    s_lshl_b32 s6, s6, 8
    s_add_u32 s82, s82, s6
    s_mov_b32 exec_lo, -1
    buffer_load_dword v13, v4, s[48:51], s82 offen
sp_1008:
    s_mov_b64 exec, -1
    s_branch kfin

dqs2:
    s_mov_b32 s85, 12
dql2:
    s_lshl2_add_u32 s82, s65, s0
    buffer_load_dwordx4 v[168:171], v1, s[56:59], s82 offen offset:0 sc1
    s_waitcnt vmcnt(0)
    v_xor_b32 v168, s44, v168
    v_xor_b32 v169, s45, v169
    v_xor_b32 v170, s46, v170
    v_xor_b32 v171, s47, v171
    v_or3_b32 v13, v168, v169, v170
    v_or_b32 v13, v13, v171
    v_and_b32 v13, s1, v13
    v_cmp_ne_u32 vcc, 0, v13
    v_lshrrev_b32 v97, 4, v168
    v_and_b32 v96, 0x07070707, v168
    v_lshrrev_b32 v99, 4, v169
    v_and_b32 v98, 0x07070707, v169
    v_lshrrev_b32 v101, 4, v170
    v_and_b32 v100, 0x07070707, v170
    v_lshrrev_b32 v103, 4, v171
    v_and_b32 v102, 0x07070707, v171
    v_and_b32 v97, 0x07070707, v97
    v_and_b32 v99, 0x07070707, v99
    v_and_b32 v101, 0x07070707, v101
    v_and_b32 v103, 0x07070707, v103
    s_cbranch_vccz dqf2
    s_sub_u32 s85, s85, 1
    s_cbranch_scc0 dql2
    s_branch dqg2

dqs3:
    s_mov_b32 s85, 12
dql3:
    s_lshl2_add_u32 s82, s66, s0
    buffer_load_dwordx4 v[184:187], v1, s[56:59], s82 offen offset:0 sc1
    s_waitcnt vmcnt(0)
    v_xor_b32 v184, s44, v184
    v_xor_b32 v185, s45, v185
    v_xor_b32 v186, s46, v186
    v_xor_b32 v187, s47, v187
    v_or3_b32 v13, v184, v185, v186
    v_or_b32 v13, v13, v187
    v_and_b32 v13, s1, v13
    v_cmp_ne_u32 vcc, 0, v13
    v_lshrrev_b32 v113, 4, v184
    v_and_b32 v112, 0x07070707, v184
    v_lshrrev_b32 v115, 4, v185
    v_and_b32 v114, 0x07070707, v185
    v_lshrrev_b32 v117, 4, v186
    v_and_b32 v116, 0x07070707, v186
    v_lshrrev_b32 v119, 4, v187
    v_and_b32 v118, 0x07070707, v187
    v_and_b32 v113, 0x07070707, v113
    v_and_b32 v115, 0x07070707, v115
    v_and_b32 v117, 0x07070707, v117
    v_and_b32 v119, 0x07070707, v119
    s_cbranch_vccz dqf3
    s_sub_u32 s85, s85, 1
    s_cbranch_scc0 dql3
    s_branch dqg3

dqs4:
    s_mov_b32 s85, 12
dql4:
    s_lshl2_add_u32 s82, s67, s0
    buffer_load_dwordx4 v[200:203], v1, s[56:59], s82 offen offset:0 sc1
    s_waitcnt vmcnt(0)
    v_xor_b32 v200, s44, v200
    v_xor_b32 v201, s45, v201
    v_xor_b32 v202, s46, v202
    v_xor_b32 v203, s47, v203
    v_or3_b32 v13, v200, v201, v202
    v_or_b32 v13, v13, v203
    v_and_b32 v13, s1, v13
    v_cmp_ne_u32 vcc, 0, v13
    v_lshrrev_b32 v97, 4, v200
    v_and_b32 v96, 0x07070707, v200
    v_lshrrev_b32 v99, 4, v201
    v_and_b32 v98, 0x07070707, v201
    v_lshrrev_b32 v101, 4, v202
    v_and_b32 v100, 0x07070707, v202
    v_lshrrev_b32 v103, 4, v203
    v_and_b32 v102, 0x07070707, v203
    v_and_b32 v97, 0x07070707, v97
    v_and_b32 v99, 0x07070707, v99
    v_and_b32 v101, 0x07070707, v101
    v_and_b32 v103, 0x07070707, v103
    s_cbranch_vccz dqf4
    s_sub_u32 s85, s85, 1
    s_cbranch_scc0 dql4
    s_branch dqg4

dqs5:
    s_mov_b32 s85, 12
dql5:
    s_lshl2_add_u32 s82, s65, s0
    buffer_load_dwordx4 v[216:219], v1, s[56:59], s82 offen offset:2048 sc1
    s_waitcnt vmcnt(0)
    v_xor_b32 v216, s44, v216
    v_xor_b32 v217, s45, v217
    v_xor_b32 v218, s46, v218
    v_xor_b32 v219, s47, v219
    v_or3_b32 v13, v216, v217, v218
    v_or_b32 v13, v13, v219
    v_and_b32 v13, s1, v13
    v_cmp_ne_u32 vcc, 0, v13
    v_lshrrev_b32 v113, 4, v216
    v_and_b32 v112, 0x07070707, v216
    v_lshrrev_b32 v115, 4, v217
    v_and_b32 v114, 0x07070707, v217
    v_lshrrev_b32 v117, 4, v218
    v_and_b32 v116, 0x07070707, v218
    v_lshrrev_b32 v119, 4, v219
    v_and_b32 v118, 0x07070707, v219
    v_and_b32 v113, 0x07070707, v113
    v_and_b32 v115, 0x07070707, v115
    v_and_b32 v117, 0x07070707, v117
    v_and_b32 v119, 0x07070707, v119
    s_cbranch_vccz dqf5
    s_sub_u32 s85, s85, 1
    s_cbranch_scc0 dql5
    s_branch dqg5

dqs6:
    s_mov_b32 s85, 12
dql6:
    s_lshl2_add_u32 s82, s66, s0
    buffer_load_dwordx4 v[232:235], v1, s[56:59], s82 offen offset:2048 sc1
    s_waitcnt vmcnt(0)
    v_xor_b32 v232, s44, v232
    v_xor_b32 v233, s45, v233
    v_xor_b32 v234, s46, v234
    v_xor_b32 v235, s47, v235
    v_or3_b32 v13, v232, v233, v234
    v_or_b32 v13, v13, v235
    v_and_b32 v13, s1, v13
    v_cmp_ne_u32 vcc, 0, v13
    v_lshrrev_b32 v97, 4, v232
    v_and_b32 v96, 0x07070707, v232
    v_lshrrev_b32 v99, 4, v233
    v_and_b32 v98, 0x07070707, v233
    v_lshrrev_b32 v101, 4, v234
    v_and_b32 v100, 0x07070707, v234
    v_lshrrev_b32 v103, 4, v235
    v_and_b32 v102, 0x07070707, v235
    v_and_b32 v97, 0x07070707, v97
    v_and_b32 v99, 0x07070707, v99
    v_and_b32 v101, 0x07070707, v101
    v_and_b32 v103, 0x07070707, v103
    s_cbranch_vccz dqf6
    s_sub_u32 s85, s85, 1
    s_cbranch_scc0 dql6
    s_branch dqg6

dqs7:
    s_mov_b32 s85, 12
dql7:
    s_lshl2_add_u32 s82, s67, s0
    buffer_load_dwordx4 v[248:251], v1, s[56:59], s82 offen offset:2048 sc1
    s_waitcnt vmcnt(0)
    v_xor_b32 v248, s44, v248
    v_xor_b32 v249, s45, v249
    v_xor_b32 v250, s46, v250
    v_xor_b32 v251, s47, v251
    v_or3_b32 v13, v248, v249, v250
    v_or_b32 v13, v13, v251
    v_and_b32 v13, s1, v13
    v_cmp_ne_u32 vcc, 0, v13
    v_lshrrev_b32 v113, 4, v248
    v_and_b32 v112, 0x07070707, v248
    v_lshrrev_b32 v115, 4, v249
    v_and_b32 v114, 0x07070707, v249
    v_lshrrev_b32 v117, 4, v250
    v_and_b32 v116, 0x07070707, v250
    v_lshrrev_b32 v119, 4, v251
    v_and_b32 v118, 0x07070707, v251
    v_and_b32 v113, 0x07070707, v113
    v_and_b32 v115, 0x07070707, v115
    v_and_b32 v117, 0x07070707, v117
    v_and_b32 v119, 0x07070707, v119
    s_cbranch_vccz dqf7
    s_sub_u32 s85, s85, 1
    s_cbranch_scc0 dql7
    s_branch dqg7

ck_6s:
    s_mov_b32 s85, 30000
ck_6l:
    buffer_load_dwordx4 a[224:227], v67, s[56:59], s64 offen offset:0 sc1
    buffer_load_dwordx4 a[228:231], v67, s[56:59], s65 offen offset:0 sc1
    buffer_load_dwordx4 a[232:235], v67, s[56:59], s66 offen offset:0 sc1
    buffer_load_dwordx4 a[236:239], v67, s[56:59], s67 offen offset:0 sc1
    s_waitcnt vmcnt(0)
    v_accvgpr_read_b32 v14, a224
    v_accvgpr_read_b32 v15, a228
    v_accvgpr_read_b32 v13, a232
    v_max3_u32 v13, v14, v15, v13
    v_accvgpr_read_b32 v14, a236
    v_max_u32 v13, v13, v14
    v_cmp_eq_u32 vcc, -1, v13
    s_cbranch_vccz ck_6r
    s_sub_u32 s85, s85, 1
    s_cbranch_scc0 ck_6l
    s_branch ck_6r

ck_7s:
    s_mov_b32 s85, 30000
ck_7l:
    buffer_load_dwordx4 a[240:243], v67, s[56:59], s64 offen offset:2048 sc1
    buffer_load_dwordx4 a[244:247], v67, s[56:59], s65 offen offset:2048 sc1
    buffer_load_dwordx4 a[248:251], v67, s[56:59], s66 offen offset:2048 sc1
    buffer_load_dwordx4 a[252:255], v67, s[56:59], s67 offen offset:2048 sc1
    s_waitcnt vmcnt(0)
    v_accvgpr_read_b32 v14, a240
    v_accvgpr_read_b32 v15, a244
    v_accvgpr_read_b32 v13, a248
    v_max3_u32 v13, v14, v15, v13
    v_accvgpr_read_b32 v14, a252
    v_max_u32 v13, v13, v14
    v_cmp_eq_u32 vcc, -1, v13
    s_cbranch_vccz ck_7r
    s_sub_u32 s85, s85, 1
    s_cbranch_scc0 ck_7l
    s_branch ck_7r

ck_8s:
    s_mov_b32 s85, 30000
ck_8l:
    buffer_load_dwordx4 v[96:99], v66, s[56:59], s64 offen offset:0 sc1
    buffer_load_dwordx4 v[100:103], v66, s[56:59], s65 offen offset:0 sc1
    buffer_load_dwordx4 v[104:107], v66, s[56:59], s66 offen offset:0 sc1
    buffer_load_dwordx4 v[108:111], v66, s[56:59], s67 offen offset:0 sc1
    s_waitcnt vmcnt(0)
    v_max3_u32 v13, v96, v100, v104
    v_max_u32 v13, v13, v108
    v_cmp_eq_u32 vcc, -1, v13
    s_cbranch_vccz ck_8r
    s_sub_u32 s85, s85, 1
    s_cbranch_scc0 ck_8l
    s_branch ck_8r

ck_9s:
    s_mov_b32 s85, 30000
ck_9l:
    buffer_load_dwordx4 v[112:115], v66, s[56:59], s64 offen offset:2048 sc1
    buffer_load_dwordx4 v[116:119], v66, s[56:59], s65 offen offset:2048 sc1
    buffer_load_dwordx4 v[120:123], v66, s[56:59], s66 offen offset:2048 sc1
    buffer_load_dwordx4 v[124:127], v66, s[56:59], s67 offen offset:2048 sc1
    s_waitcnt vmcnt(0)
    v_max3_u32 v13, v112, v116, v120
    v_max_u32 v13, v13, v124
    v_cmp_eq_u32 vcc, -1, v13
    s_cbranch_vccz ck_9r
    s_sub_u32 s85, s85, 1
    s_cbranch_scc0 ck_9l
    s_branch ck_9r

ck_10s:
    s_mov_b32 s85, 30000
ck_10l:
    buffer_load_dwordx4 a[192:195], v65, s[56:59], s64 offen offset:0 sc1
    buffer_load_dwordx4 a[196:199], v65, s[56:59], s65 offen offset:0 sc1
    buffer_load_dwordx4 a[200:203], v65, s[56:59], s66 offen offset:0 sc1
    buffer_load_dwordx4 a[204:207], v65, s[56:59], s67 offen offset:0 sc1
    s_waitcnt vmcnt(0)
    v_accvgpr_read_b32 v14, a192
    v_accvgpr_read_b32 v15, a196
    v_accvgpr_read_b32 v13, a200
    v_max3_u32 v13, v14, v15, v13
    v_accvgpr_read_b32 v14, a204
    v_max_u32 v13, v13, v14
    v_cmp_eq_u32 vcc, -1, v13
    s_cbranch_vccz ck_10r
    s_sub_u32 s85, s85, 1
    s_cbranch_scc0 ck_10l
    s_branch ck_10r

ck_11s:
    s_mov_b32 s85, 30000
ck_11l:
    buffer_load_dwordx4 a[144:147], v65, s[56:59], s64 offen offset:2048 sc1
    buffer_load_dwordx4 a[148:151], v65, s[56:59], s65 offen offset:2048 sc1
    buffer_load_dwordx4 a[152:155], v65, s[56:59], s66 offen offset:2048 sc1
    buffer_load_dwordx4 a[156:159], v65, s[56:59], s67 offen offset:2048 sc1
    s_waitcnt vmcnt(0)
    v_accvgpr_read_b32 v14, a144
    v_accvgpr_read_b32 v15, a148
    v_accvgpr_read_b32 v13, a152
    v_max3_u32 v13, v14, v15, v13
    v_accvgpr_read_b32 v14, a156
    v_max_u32 v13, v13, v14
    v_cmp_eq_u32 vcc, -1, v13
    s_cbranch_vccz ck_11r
    s_sub_u32 s85, s85, 1
    s_cbranch_scc0 ck_11l
    s_branch ck_11r

ck_12s:
    s_mov_b32 s85, 30000
ck_12l:
    buffer_load_dwordx4 a[176:179], v64, s[56:59], s64 offen offset:0 sc1
    buffer_load_dwordx4 a[180:183], v64, s[56:59], s65 offen offset:0 sc1
    buffer_load_dwordx4 a[184:187], v64, s[56:59], s66 offen offset:0 sc1
    buffer_load_dwordx4 a[188:191], v64, s[56:59], s67 offen offset:0 sc1
    s_waitcnt vmcnt(0)
    v_accvgpr_read_b32 v14, a176
    v_accvgpr_read_b32 v15, a180
    v_accvgpr_read_b32 v13, a184
    v_max3_u32 v13, v14, v15, v13
    v_accvgpr_read_b32 v14, a188
    v_max_u32 v13, v13, v14
    v_cmp_eq_u32 vcc, -1, v13
    s_cbranch_vccz ck_12r
    s_sub_u32 s85, s85, 1
    s_cbranch_scc0 ck_12l
    s_branch ck_12r

ck_13s:
    s_mov_b32 s85, 30000
ck_13l:
    buffer_load_dwordx4 a[208:211], v64, s[56:59], s64 offen offset:2048 sc1
    buffer_load_dwordx4 a[212:215], v64, s[56:59], s65 offen offset:2048 sc1
    buffer_load_dwordx4 a[216:219], v64, s[56:59], s66 offen offset:2048 sc1
    buffer_load_dwordx4 a[220:223], v64, s[56:59], s67 offen offset:2048 sc1
    s_waitcnt vmcnt(0)
    v_accvgpr_read_b32 v14, a208
    v_accvgpr_read_b32 v15, a212
    v_accvgpr_read_b32 v13, a216
    v_max3_u32 v13, v14, v15, v13
    v_accvgpr_read_b32 v14, a220
    v_max_u32 v13, v13, v14
    v_cmp_eq_u32 vcc, -1, v13
    s_cbranch_vccz ck_13r
    s_sub_u32 s85, s85, 1
    s_cbranch_scc0 ck_13l
    s_branch ck_13r

gt_16s:
    s_mov_b32 s85, 30000
gt_16l:
    buffer_load_dword v2, v29, s[56:59], 0 offen sc1
    buffer_load_dwordx4 v[180:183], v17, s[56:59], s74 offen sc1
    buffer_load_dwordx4 v[188:191], v17, s[56:59], s75 offen sc1
    buffer_load_dwordx4 v[196:199], v17, s[56:59], s76 offen sc1
    buffer_load_dwordx4 v[204:207], v17, s[56:59], s77 offen sc1
    buffer_load_dwordx4 v[212:215], v17, s[56:59], s78 offen sc1
    buffer_load_dwordx4 v[220:223], v17, s[56:59], s79 offen sc1
    buffer_load_dwordx4 v[228:231], v17, s[56:59], s80 offen sc1
    s_waitcnt vmcnt(7)
    v_cmp_eq_u32 vcc, -1, v2
    s_cbranch_vccz gt_16e
    s_sub_u32 s85, s85, 1
    s_cbranch_scc0 gt_16l
gt_16e:
    s_waitcnt vmcnt(0)
    s_branch gt_16o

ck_17s:
    s_mov_b32 s85, 30000
ck_17l:
    buffer_load_dwordx4 v[180:183], v17, s[56:59], s74 offen sc1
    buffer_load_dwordx4 v[188:191], v17, s[56:59], s75 offen sc1
    s_waitcnt vmcnt(0)
    v_max_u32 v13, v180, v188
    v_cmp_eq_u32 vcc, -1, v13
    s_cbranch_vccz ck_17r
    s_sub_u32 s85, s85, 1
    s_cbranch_scc0 ck_17l
    s_branch ck_17r

ck_18s:
    s_mov_b32 s85, 30000
ck_18l:
    buffer_load_dwordx4 v[196:199], v17, s[56:59], s76 offen sc1
    buffer_load_dwordx4 v[204:207], v17, s[56:59], s77 offen sc1
    s_waitcnt vmcnt(0)
    v_max_u32 v13, v196, v204
    v_cmp_eq_u32 vcc, -1, v13
    s_cbranch_vccz ck_18r
    s_sub_u32 s85, s85, 1
    s_cbranch_scc0 ck_18l
    s_branch ck_18r

ck_19s:
    s_mov_b32 s85, 30000
ck_19l:
    buffer_load_dwordx4 v[212:215], v17, s[56:59], s78 offen sc1
    buffer_load_dwordx4 v[220:223], v17, s[56:59], s79 offen sc1
    buffer_load_dwordx4 v[228:231], v17, s[56:59], s80 offen sc1
    s_waitcnt vmcnt(0)
    v_max3_u32 v13, v212, v220, v228
    v_cmp_eq_u32 vcc, -1, v13
    s_cbranch_vccz ck_19r
    s_sub_u32 s85, s85, 1
    s_cbranch_scc0 ck_19l
    s_branch ck_19r

ck_20s:
    s_mov_b32 s85, 30000
ck_20l:
    buffer_load_dwordx4 v[176:179], v16, s[56:59], s74 offen sc1
    buffer_load_dwordx4 v[184:187], v16, s[56:59], s75 offen sc1
    buffer_load_dwordx4 v[192:195], v16, s[56:59], s76 offen sc1
    buffer_load_dwordx4 v[200:203], v16, s[56:59], s77 offen sc1
    s_waitcnt vmcnt(0)
    v_max3_u32 v13, v176, v184, v192
    v_max_u32 v13, v13, v200
    v_cmp_eq_u32 vcc, -1, v13
    s_cbranch_vccz ck_20r
    s_sub_u32 s85, s85, 1
    s_cbranch_scc0 ck_20l
    s_branch ck_20r

ck_21s:
    s_mov_b32 s85, 30000
ck_21l:
    buffer_load_dwordx4 v[208:211], v16, s[56:59], s78 offen sc1
    buffer_load_dwordx4 v[216:219], v16, s[56:59], s79 offen sc1
    buffer_load_dwordx4 v[224:227], v16, s[56:59], s80 offen sc1
    s_waitcnt vmcnt(0)
    v_max3_u32 v13, v208, v216, v224
    v_cmp_eq_u32 vcc, -1, v13
    s_cbranch_vccz ck_21r
    s_sub_u32 s85, s85, 1
    s_cbranch_scc0 ck_21l
    s_branch ck_21r

ck_22s:
    s_mov_b32 s85, 30000
ck_22l:
    buffer_load_dwordx4 v[236:239], v19, s[56:59], s74 offen sc1
    buffer_load_dwordx4 v[244:247], v19, s[56:59], s75 offen sc1
    buffer_load_dwordx4 v[252:255], v19, s[56:59], s76 offen sc1
    buffer_load_dwordx4 a[228:231], v19, s[56:59], s77 offen sc1
    s_waitcnt vmcnt(0)
    v_max3_u32 v13, v236, v244, v252
    v_accvgpr_read_b32 v14, a228
    v_max_u32 v13, v13, v14
    v_cmp_eq_u32 vcc, -1, v13
    s_cbranch_vccz ck_22r
    s_sub_u32 s85, s85, 1
    s_cbranch_scc0 ck_22l
    s_branch ck_22r

ck_23s:
    s_mov_b32 s85, 30000
ck_23l:
    buffer_load_dwordx4 a[236:239], v19, s[56:59], s78 offen sc1
    buffer_load_dwordx4 a[244:247], v19, s[56:59], s79 offen sc1
    buffer_load_dwordx4 a[252:255], v19, s[56:59], s80 offen sc1
    s_waitcnt vmcnt(0)
    v_accvgpr_read_b32 v14, a236
    v_accvgpr_read_b32 v15, a244
    v_accvgpr_read_b32 v13, a252
    v_max3_u32 v13, v14, v15, v13
    v_cmp_eq_u32 vcc, -1, v13
    s_cbranch_vccz ck_23r
    s_sub_u32 s85, s85, 1
    s_cbranch_scc0 ck_23l
    s_branch ck_23r

ck_24s:
    s_mov_b32 s85, 30000
ck_24l:
    buffer_load_dwordx4 v[232:235], v18, s[56:59], s74 offen sc1
    buffer_load_dwordx4 v[240:243], v18, s[56:59], s75 offen sc1
    buffer_load_dwordx4 v[248:251], v18, s[56:59], s76 offen sc1
    buffer_load_dwordx4 a[224:227], v18, s[56:59], s77 offen sc1
    s_waitcnt vmcnt(0)
    v_max3_u32 v13, v232, v240, v248
    v_accvgpr_read_b32 v14, a224
    v_max_u32 v13, v13, v14
    v_cmp_eq_u32 vcc, -1, v13
    s_cbranch_vccz ck_24r
    s_sub_u32 s85, s85, 1
    s_cbranch_scc0 ck_24l
    s_branch ck_24r

ck_25s:
    s_mov_b32 s85, 30000
ck_25l:
    buffer_load_dwordx4 a[232:235], v18, s[56:59], s78 offen sc1
    buffer_load_dwordx4 a[240:243], v18, s[56:59], s79 offen sc1
    buffer_load_dwordx4 a[248:251], v18, s[56:59], s80 offen sc1
    s_waitcnt vmcnt(0)
    v_accvgpr_read_b32 v14, a232
    v_accvgpr_read_b32 v15, a240
    v_accvgpr_read_b32 v13, a248
    v_max3_u32 v13, v14, v15, v13
    v_cmp_eq_u32 vcc, -1, v13
    s_cbranch_vccz ck_25r
    s_sub_u32 s85, s85, 1
    s_cbranch_scc0 ck_25l
    s_branch ck_25r

ck_26s:
    s_mov_b32 s85, 30000
ck_26l:
    buffer_load_dwordx4 v[180:183], v21, s[56:59], s74 offen sc1
    buffer_load_dwordx4 v[188:191], v21, s[56:59], s75 offen sc1
    buffer_load_dwordx4 v[196:199], v21, s[56:59], s76 offen sc1
    buffer_load_dwordx4 v[204:207], v21, s[56:59], s77 offen sc1
    s_waitcnt vmcnt(0)
    v_max3_u32 v13, v180, v188, v196
    v_max_u32 v13, v13, v204
    v_cmp_eq_u32 vcc, -1, v13
    s_cbranch_vccz ck_26r
    s_sub_u32 s85, s85, 1
    s_cbranch_scc0 ck_26l
    s_branch ck_26r

ck_27s:
    s_mov_b32 s85, 30000
ck_27l:
    buffer_load_dwordx4 v[212:215], v21, s[56:59], s78 offen sc1
    buffer_load_dwordx4 v[220:223], v21, s[56:59], s79 offen sc1
    buffer_load_dwordx4 v[228:231], v21, s[56:59], s80 offen sc1
    s_waitcnt vmcnt(0)
    v_max3_u32 v13, v212, v220, v228
    v_cmp_eq_u32 vcc, -1, v13
    s_cbranch_vccz ck_27r
    s_sub_u32 s85, s85, 1
    s_cbranch_scc0 ck_27l
    s_branch ck_27r

ck_28s:
    s_mov_b32 s85, 30000
ck_28l:
    buffer_load_dwordx4 v[176:179], v20, s[56:59], s74 offen sc1
    buffer_load_dwordx4 v[184:187], v20, s[56:59], s75 offen sc1
    buffer_load_dwordx4 v[192:195], v20, s[56:59], s76 offen sc1
    buffer_load_dwordx4 v[200:203], v20, s[56:59], s77 offen sc1
    s_waitcnt vmcnt(0)
    v_max3_u32 v13, v176, v184, v192
    v_max_u32 v13, v13, v200
    v_cmp_eq_u32 vcc, -1, v13
    s_cbranch_vccz ck_28r
    s_sub_u32 s85, s85, 1
    s_cbranch_scc0 ck_28l
    s_branch ck_28r

ck_29s:
    s_mov_b32 s85, 30000
ck_29l:
    buffer_load_dwordx4 v[208:211], v20, s[56:59], s78 offen sc1
    buffer_load_dwordx4 v[216:219], v20, s[56:59], s79 offen sc1
    buffer_load_dwordx4 v[224:227], v20, s[56:59], s80 offen sc1
    s_waitcnt vmcnt(0)
    v_max3_u32 v13, v208, v216, v224
    v_cmp_eq_u32 vcc, -1, v13
    s_cbranch_vccz ck_29r
    s_sub_u32 s85, s85, 1
    s_cbranch_scc0 ck_29l
    s_branch ck_29r

ck_30s:
    s_mov_b32 s85, 30000
ck_30l:
    buffer_load_dwordx4 v[236:239], v23, s[56:59], s74 offen sc1
    buffer_load_dwordx4 v[244:247], v23, s[56:59], s75 offen sc1
    buffer_load_dwordx4 v[252:255], v23, s[56:59], s76 offen sc1
    buffer_load_dwordx4 a[228:231], v23, s[56:59], s77 offen sc1
    s_waitcnt vmcnt(0)
    v_max3_u32 v13, v236, v244, v252
    v_accvgpr_read_b32 v14, a228
    v_max_u32 v13, v13, v14
    v_cmp_eq_u32 vcc, -1, v13
    s_cbranch_vccz ck_30r
    s_sub_u32 s85, s85, 1
    s_cbranch_scc0 ck_30l
    s_branch ck_30r

ck_31s:
    s_mov_b32 s85, 30000
ck_31l:
    buffer_load_dwordx4 a[236:239], v23, s[56:59], s78 offen sc1
    buffer_load_dwordx4 a[244:247], v23, s[56:59], s79 offen sc1
    buffer_load_dwordx4 a[252:255], v23, s[56:59], s80 offen sc1
    s_waitcnt vmcnt(0)
    v_accvgpr_read_b32 v14, a236
    v_accvgpr_read_b32 v15, a244
    v_accvgpr_read_b32 v13, a252
    v_max3_u32 v13, v14, v15, v13
    v_cmp_eq_u32 vcc, -1, v13
    s_cbranch_vccz ck_31r
    s_sub_u32 s85, s85, 1
    s_cbranch_scc0 ck_31l
    s_branch ck_31r

ck_32s:
    s_mov_b32 s85, 30000
ck_32l:
    buffer_load_dwordx4 v[232:235], v22, s[56:59], s74 offen sc1
    buffer_load_dwordx4 v[240:243], v22, s[56:59], s75 offen sc1
    buffer_load_dwordx4 v[248:251], v22, s[56:59], s76 offen sc1
    buffer_load_dwordx4 a[224:227], v22, s[56:59], s77 offen sc1
    s_waitcnt vmcnt(0)
    v_max3_u32 v13, v232, v240, v248
    v_accvgpr_read_b32 v14, a224
    v_max_u32 v13, v13, v14
    v_cmp_eq_u32 vcc, -1, v13
    s_cbranch_vccz ck_32r
    s_sub_u32 s85, s85, 1
    s_cbranch_scc0 ck_32l
    s_branch ck_32r

ck_33s:
    s_mov_b32 s85, 30000
ck_33l:
    buffer_load_dwordx4 a[232:235], v22, s[56:59], s78 offen sc1
    buffer_load_dwordx4 a[240:243], v22, s[56:59], s79 offen sc1
    buffer_load_dwordx4 a[248:251], v22, s[56:59], s80 offen sc1
    s_waitcnt vmcnt(0)
    v_accvgpr_read_b32 v14, a232
    v_accvgpr_read_b32 v15, a240
    v_accvgpr_read_b32 v13, a248
    v_max3_u32 v13, v14, v15, v13
    v_cmp_eq_u32 vcc, -1, v13
    s_cbranch_vccz ck_33r
    s_sub_u32 s85, s85, 1
    s_cbranch_scc0 ck_33l
    s_branch ck_33r

kend:
    s_endpgm
dqg0:
    v_bfe_u32 v13, v0, 3, 4
    s_and_b32 s82, s68, 2
    v_xor_b32 v13, s82, v13
    v_lshlrev_b32 v13, 3, v13
    s_lshl_b32 s82, s71, 7
    buffer_load_dwordx2 v[128:129], v13, s[36:39], s82 offen
    buffer_load_dwordx2 v[132:133], v13, s[40:43], s82 offen
    s_waitcnt vmcnt(0)
    v_and_b32 v131, 0xffff0000, v129
    v_lshlrev_b32 v130, 16, v129
    v_and_b32 v129, 0xffff0000, v128
    v_lshlrev_b32 v128, 16, v128
    v_and_b32 v135, 0xffff0000, v133
    v_lshlrev_b32 v134, 16, v133
    v_and_b32 v133, 0xffff0000, v132
    v_lshlrev_b32 v132, 16, v132
    v_cvt_f32_i32 v32, v32
    v_cvt_f32_i32 v36, v36
    v_cvt_pk_bf16_f32 v32, v32, v36
    v_and_b32 v36, 0xffff0000, v32
    v_lshlrev_b32 v32, 16, v32
    v_sub_f32 v36, v36, v132
    v_sub_f32 v32, v32, v132
    v_cvt_pk_bf16_f32 v32, v32, v36
    v_and_b32 v36, 0xffff0000, v32
    v_lshlrev_b32 v32, 16, v32
    v_mul_f32 v36, v36, v128
    v_mul_f32 v32, v32, v128
    v_cvt_pk_bf16_f32 v32, v32, v36
    v_cvt_f32_i32 v33, v33
    v_cvt_f32_i32 v37, v37
    v_cvt_pk_bf16_f32 v33, v33, v37
    v_and_b32 v37, 0xffff0000, v33
    v_lshlrev_b32 v33, 16, v33
    v_sub_f32 v37, v37, v133
    v_sub_f32 v33, v33, v133
    v_cvt_pk_bf16_f32 v33, v33, v37
    v_and_b32 v37, 0xffff0000, v33
    v_lshlrev_b32 v33, 16, v33
    v_mul_f32 v37, v37, v129
    v_mul_f32 v33, v33, v129
    v_cvt_pk_bf16_f32 v33, v33, v37
    v_cvt_f32_i32 v34, v34
    v_cvt_f32_i32 v38, v38
    v_cvt_pk_bf16_f32 v34, v34, v38
    v_and_b32 v38, 0xffff0000, v34
    v_lshlrev_b32 v34, 16, v34
    v_sub_f32 v38, v38, v134
    v_sub_f32 v34, v34, v134
    v_cvt_pk_bf16_f32 v34, v34, v38
    v_and_b32 v38, 0xffff0000, v34
    v_lshlrev_b32 v34, 16, v34
    v_mul_f32 v38, v38, v130
    v_mul_f32 v34, v34, v130
    v_cvt_pk_bf16_f32 v34, v34, v38
    v_cvt_f32_i32 v35, v35
    v_cvt_f32_i32 v39, v39
    v_cvt_pk_bf16_f32 v35, v35, v39
    v_and_b32 v39, 0xffff0000, v35
    v_lshlrev_b32 v35, 16, v35
    v_sub_f32 v39, v39, v135
    v_sub_f32 v35, v35, v135
    v_cvt_pk_bf16_f32 v35, v35, v39
    v_and_b32 v39, 0xffff0000, v35
    v_lshlrev_b32 v35, 16, v35
    v_mul_f32 v39, v39, v131
    v_mul_f32 v35, v35, v131
    v_cvt_pk_bf16_f32 v35, v35, v39
    v_cvt_f32_i32 v40, v40
    v_cvt_f32_i32 v44, v44
    v_cvt_pk_bf16_f32 v40, v40, v44
    v_and_b32 v44, 0xffff0000, v40
    v_lshlrev_b32 v40, 16, v40
    v_sub_f32 v44, v44, v132
    v_sub_f32 v40, v40, v132
    v_cvt_pk_bf16_f32 v40, v40, v44
    v_and_b32 v44, 0xffff0000, v40
    v_lshlrev_b32 v40, 16, v40
    v_mul_f32 v44, v44, v128
    v_mul_f32 v40, v40, v128
    v_cvt_pk_bf16_f32 v40, v40, v44
    v_cvt_f32_i32 v41, v41
    v_cvt_f32_i32 v45, v45
    v_cvt_pk_bf16_f32 v41, v41, v45
    v_and_b32 v45, 0xffff0000, v41
    v_lshlrev_b32 v41, 16, v41
    v_sub_f32 v45, v45, v133
    v_sub_f32 v41, v41, v133
    v_cvt_pk_bf16_f32 v41, v41, v45
    v_and_b32 v45, 0xffff0000, v41
    v_lshlrev_b32 v41, 16, v41
    v_mul_f32 v45, v45, v129
    v_mul_f32 v41, v41, v129
    v_cvt_pk_bf16_f32 v41, v41, v45
    v_cvt_f32_i32 v42, v42
    v_cvt_f32_i32 v46, v46
    v_cvt_pk_bf16_f32 v42, v42, v46
    v_and_b32 v46, 0xffff0000, v42
    v_lshlrev_b32 v42, 16, v42
    v_sub_f32 v46, v46, v134
    v_sub_f32 v42, v42, v134
    v_cvt_pk_bf16_f32 v42, v42, v46
    v_and_b32 v46, 0xffff0000, v42
    v_lshlrev_b32 v42, 16, v42
    v_mul_f32 v46, v46, v130
    v_mul_f32 v42, v42, v130
    v_cvt_pk_bf16_f32 v42, v42, v46
    v_cvt_f32_i32 v43, v43
    v_cvt_f32_i32 v47, v47
    v_cvt_pk_bf16_f32 v43, v43, v47
    v_and_b32 v47, 0xffff0000, v43
    v_lshlrev_b32 v43, 16, v43
    v_sub_f32 v47, v47, v135
    v_sub_f32 v43, v43, v135
    v_cvt_pk_bf16_f32 v43, v43, v47
    v_and_b32 v47, 0xffff0000, v43
    v_lshlrev_b32 v43, 16, v43
    v_mul_f32 v47, v47, v131
    v_mul_f32 v43, v43, v131
    v_cvt_pk_bf16_f32 v43, v43, v47
    v_cvt_f32_i32 v48, v48
    v_cvt_f32_i32 v52, v52
    v_cvt_pk_bf16_f32 v48, v48, v52
    v_and_b32 v52, 0xffff0000, v48
    v_lshlrev_b32 v48, 16, v48
    v_sub_f32 v52, v52, v132
    v_sub_f32 v48, v48, v132
    v_cvt_pk_bf16_f32 v48, v48, v52
    v_and_b32 v52, 0xffff0000, v48
    v_lshlrev_b32 v48, 16, v48
    v_mul_f32 v52, v52, v128
    v_mul_f32 v48, v48, v128
    v_cvt_pk_bf16_f32 v48, v48, v52
    v_cvt_f32_i32 v49, v49
    v_cvt_f32_i32 v53, v53
    v_cvt_pk_bf16_f32 v49, v49, v53
    v_and_b32 v53, 0xffff0000, v49
    v_lshlrev_b32 v49, 16, v49
    v_sub_f32 v53, v53, v133
    v_sub_f32 v49, v49, v133
    v_cvt_pk_bf16_f32 v49, v49, v53
    v_and_b32 v53, 0xffff0000, v49
    v_lshlrev_b32 v49, 16, v49
    v_mul_f32 v53, v53, v129
    v_mul_f32 v49, v49, v129
    v_cvt_pk_bf16_f32 v49, v49, v53
    v_cvt_f32_i32 v50, v50
    v_cvt_f32_i32 v54, v54
    v_cvt_pk_bf16_f32 v50, v50, v54
    v_and_b32 v54, 0xffff0000, v50
    v_lshlrev_b32 v50, 16, v50
    v_sub_f32 v54, v54, v134
    v_sub_f32 v50, v50, v134
    v_cvt_pk_bf16_f32 v50, v50, v54
    v_and_b32 v54, 0xffff0000, v50
    v_lshlrev_b32 v50, 16, v50
    v_mul_f32 v54, v54, v130
    v_mul_f32 v50, v50, v130
    v_cvt_pk_bf16_f32 v50, v50, v54
    v_cvt_f32_i32 v51, v51
    v_cvt_f32_i32 v55, v55
    v_cvt_pk_bf16_f32 v51, v51, v55
    v_and_b32 v55, 0xffff0000, v51
    v_lshlrev_b32 v51, 16, v51
    v_sub_f32 v55, v55, v135
    v_sub_f32 v51, v51, v135
    v_cvt_pk_bf16_f32 v51, v51, v55
    v_and_b32 v55, 0xffff0000, v51
    v_lshlrev_b32 v51, 16, v51
    v_mul_f32 v55, v55, v131
    v_mul_f32 v51, v51, v131
    v_cvt_pk_bf16_f32 v51, v51, v55
    v_cvt_f32_i32 v56, v56
    v_cvt_f32_i32 v60, v60
    v_cvt_pk_bf16_f32 v56, v56, v60
    v_and_b32 v60, 0xffff0000, v56
    v_lshlrev_b32 v56, 16, v56
    v_sub_f32 v60, v60, v132
    v_sub_f32 v56, v56, v132
    v_cvt_pk_bf16_f32 v56, v56, v60
    v_and_b32 v60, 0xffff0000, v56
    v_lshlrev_b32 v56, 16, v56
    v_mul_f32 v60, v60, v128
    v_mul_f32 v56, v56, v128
    v_cvt_pk_bf16_f32 v56, v56, v60
    v_cvt_f32_i32 v57, v57
    v_cvt_f32_i32 v61, v61
    v_cvt_pk_bf16_f32 v57, v57, v61
    v_and_b32 v61, 0xffff0000, v57
    v_lshlrev_b32 v57, 16, v57
    v_sub_f32 v61, v61, v133
    v_sub_f32 v57, v57, v133
    v_cvt_pk_bf16_f32 v57, v57, v61
    v_and_b32 v61, 0xffff0000, v57
    v_lshlrev_b32 v57, 16, v57
    v_mul_f32 v61, v61, v129
    v_mul_f32 v57, v57, v129
    v_cvt_pk_bf16_f32 v57, v57, v61
    v_cvt_f32_i32 v58, v58
    v_cvt_f32_i32 v62, v62
    v_cvt_pk_bf16_f32 v58, v58, v62
    v_and_b32 v62, 0xffff0000, v58
    v_lshlrev_b32 v58, 16, v58
    v_sub_f32 v62, v62, v134
    v_sub_f32 v58, v58, v134
    v_cvt_pk_bf16_f32 v58, v58, v62
    v_and_b32 v62, 0xffff0000, v58
    v_lshlrev_b32 v58, 16, v58
    v_mul_f32 v62, v62, v130
    v_mul_f32 v58, v58, v130
    v_cvt_pk_bf16_f32 v58, v58, v62
    v_cvt_f32_i32 v59, v59
    v_cvt_f32_i32 v63, v63
    v_cvt_pk_bf16_f32 v59, v59, v63
    v_and_b32 v63, 0xffff0000, v59
    v_lshlrev_b32 v59, 16, v59
    v_sub_f32 v63, v63, v135
    v_sub_f32 v59, v59, v135
    v_cvt_pk_bf16_f32 v59, v59, v63
    v_and_b32 v63, 0xffff0000, v59
    v_lshlrev_b32 v59, 16, v59
    v_mul_f32 v63, v63, v131
    v_mul_f32 v59, v59, v131
    v_cvt_pk_bf16_f32 v59, v59, v63
    v_mov_b32 v128, v32
    v_mov_b32 v132, v33
    v_mov_b32 v136, v34
    v_mov_b32 v140, v35
    v_mov_b32 v129, v40
    v_mov_b32 v133, v41
    v_mov_b32 v137, v42
    v_mov_b32 v141, v43
    v_mov_b32 v130, v48
    v_mov_b32 v134, v49
    v_mov_b32 v138, v50
    v_mov_b32 v142, v51
    v_mov_b32 v131, v56
    v_mov_b32 v135, v57
    v_mov_b32 v139, v58
    v_mov_b32 v143, v59
    s_branch dqr0

dqg1:
    v_bfe_u32 v13, v0, 3, 4
    s_and_b32 s82, s68, 2
    v_xor_b32 v13, s82, v13
    v_lshlrev_b32 v13, 3, v13
    s_lshl_b32 s82, s71, 7
    buffer_load_dwordx2 v[144:145], v13, s[36:39], s82 offen
    buffer_load_dwordx2 v[148:149], v13, s[40:43], s82 offen
    s_waitcnt vmcnt(0)
    v_and_b32 v147, 0xffff0000, v145
    v_lshlrev_b32 v146, 16, v145
    v_and_b32 v145, 0xffff0000, v144
    v_lshlrev_b32 v144, 16, v144
    v_and_b32 v151, 0xffff0000, v149
    v_lshlrev_b32 v150, 16, v149
    v_and_b32 v149, 0xffff0000, v148
    v_lshlrev_b32 v148, 16, v148
    v_cvt_f32_i32 v64, v64
    v_cvt_f32_i32 v68, v68
    v_cvt_pk_bf16_f32 v64, v64, v68
    v_and_b32 v68, 0xffff0000, v64
    v_lshlrev_b32 v64, 16, v64
    v_sub_f32 v68, v68, v148
    v_sub_f32 v64, v64, v148
    v_cvt_pk_bf16_f32 v64, v64, v68
    v_and_b32 v68, 0xffff0000, v64
    v_lshlrev_b32 v64, 16, v64
    v_mul_f32 v68, v68, v144
    v_mul_f32 v64, v64, v144
    v_cvt_pk_bf16_f32 v64, v64, v68
    v_cvt_f32_i32 v65, v65
    v_cvt_f32_i32 v69, v69
    v_cvt_pk_bf16_f32 v65, v65, v69
    v_and_b32 v69, 0xffff0000, v65
    v_lshlrev_b32 v65, 16, v65
    v_sub_f32 v69, v69, v149
    v_sub_f32 v65, v65, v149
    v_cvt_pk_bf16_f32 v65, v65, v69
    v_and_b32 v69, 0xffff0000, v65
    v_lshlrev_b32 v65, 16, v65
    v_mul_f32 v69, v69, v145
    v_mul_f32 v65, v65, v145
    v_cvt_pk_bf16_f32 v65, v65, v69
    v_cvt_f32_i32 v66, v66
    v_cvt_f32_i32 v70, v70
    v_cvt_pk_bf16_f32 v66, v66, v70
    v_and_b32 v70, 0xffff0000, v66
    v_lshlrev_b32 v66, 16, v66
    v_sub_f32 v70, v70, v150
    v_sub_f32 v66, v66, v150
    v_cvt_pk_bf16_f32 v66, v66, v70
    v_and_b32 v70, 0xffff0000, v66
    v_lshlrev_b32 v66, 16, v66
    v_mul_f32 v70, v70, v146
    v_mul_f32 v66, v66, v146
    v_cvt_pk_bf16_f32 v66, v66, v70
    v_cvt_f32_i32 v67, v67
    v_cvt_f32_i32 v71, v71
    v_cvt_pk_bf16_f32 v67, v67, v71
    v_and_b32 v71, 0xffff0000, v67
    v_lshlrev_b32 v67, 16, v67
    v_sub_f32 v71, v71, v151
    v_sub_f32 v67, v67, v151
    v_cvt_pk_bf16_f32 v67, v67, v71
    v_and_b32 v71, 0xffff0000, v67
    v_lshlrev_b32 v67, 16, v67
    v_mul_f32 v71, v71, v147
    v_mul_f32 v67, v67, v147
    v_cvt_pk_bf16_f32 v67, v67, v71
    v_cvt_f32_i32 v72, v72
    v_cvt_f32_i32 v76, v76
    v_cvt_pk_bf16_f32 v72, v72, v76
    v_and_b32 v76, 0xffff0000, v72
    v_lshlrev_b32 v72, 16, v72
    v_sub_f32 v76, v76, v148
    v_sub_f32 v72, v72, v148
    v_cvt_pk_bf16_f32 v72, v72, v76
    v_and_b32 v76, 0xffff0000, v72
    v_lshlrev_b32 v72, 16, v72
    v_mul_f32 v76, v76, v144
    v_mul_f32 v72, v72, v144
    v_cvt_pk_bf16_f32 v72, v72, v76
    v_cvt_f32_i32 v73, v73
    v_cvt_f32_i32 v77, v77
    v_cvt_pk_bf16_f32 v73, v73, v77
    v_and_b32 v77, 0xffff0000, v73
    v_lshlrev_b32 v73, 16, v73
    v_sub_f32 v77, v77, v149
    v_sub_f32 v73, v73, v149
    v_cvt_pk_bf16_f32 v73, v73, v77
    v_and_b32 v77, 0xffff0000, v73
    v_lshlrev_b32 v73, 16, v73
    v_mul_f32 v77, v77, v145
    v_mul_f32 v73, v73, v145
    v_cvt_pk_bf16_f32 v73, v73, v77
    v_cvt_f32_i32 v74, v74
    v_cvt_f32_i32 v78, v78
    v_cvt_pk_bf16_f32 v74, v74, v78
    v_and_b32 v78, 0xffff0000, v74
    v_lshlrev_b32 v74, 16, v74
    v_sub_f32 v78, v78, v150
    v_sub_f32 v74, v74, v150
    v_cvt_pk_bf16_f32 v74, v74, v78
    v_and_b32 v78, 0xffff0000, v74
    v_lshlrev_b32 v74, 16, v74
    v_mul_f32 v78, v78, v146
    v_mul_f32 v74, v74, v146
    v_cvt_pk_bf16_f32 v74, v74, v78
    v_cvt_f32_i32 v75, v75
    v_cvt_f32_i32 v79, v79
    v_cvt_pk_bf16_f32 v75, v75, v79
    v_and_b32 v79, 0xffff0000, v75
    v_lshlrev_b32 v75, 16, v75
    v_sub_f32 v79, v79, v151
    v_sub_f32 v75, v75, v151
    v_cvt_pk_bf16_f32 v75, v75, v79
    v_and_b32 v79, 0xffff0000, v75
    v_lshlrev_b32 v75, 16, v75
    v_mul_f32 v79, v79, v147
    v_mul_f32 v75, v75, v147
    v_cvt_pk_bf16_f32 v75, v75, v79
    v_cvt_f32_i32 v80, v80
    v_cvt_f32_i32 v84, v84
    v_cvt_pk_bf16_f32 v80, v80, v84
    v_and_b32 v84, 0xffff0000, v80
    v_lshlrev_b32 v80, 16, v80
    v_sub_f32 v84, v84, v148
    v_sub_f32 v80, v80, v148
    v_cvt_pk_bf16_f32 v80, v80, v84
    v_and_b32 v84, 0xffff0000, v80
    v_lshlrev_b32 v80, 16, v80
    v_mul_f32 v84, v84, v144
    v_mul_f32 v80, v80, v144
    v_cvt_pk_bf16_f32 v80, v80, v84
    v_cvt_f32_i32 v81, v81
    v_cvt_f32_i32 v85, v85
    v_cvt_pk_bf16_f32 v81, v81, v85
    v_and_b32 v85, 0xffff0000, v81
    v_lshlrev_b32 v81, 16, v81
    v_sub_f32 v85, v85, v149
    v_sub_f32 v81, v81, v149
    v_cvt_pk_bf16_f32 v81, v81, v85
    v_and_b32 v85, 0xffff0000, v81
    v_lshlrev_b32 v81, 16, v81
    v_mul_f32 v85, v85, v145
    v_mul_f32 v81, v81, v145
    v_cvt_pk_bf16_f32 v81, v81, v85
    v_cvt_f32_i32 v82, v82
    v_cvt_f32_i32 v86, v86
    v_cvt_pk_bf16_f32 v82, v82, v86
    v_and_b32 v86, 0xffff0000, v82
    v_lshlrev_b32 v82, 16, v82
    v_sub_f32 v86, v86, v150
    v_sub_f32 v82, v82, v150
    v_cvt_pk_bf16_f32 v82, v82, v86
    v_and_b32 v86, 0xffff0000, v82
    v_lshlrev_b32 v82, 16, v82
    v_mul_f32 v86, v86, v146
    v_mul_f32 v82, v82, v146
    v_cvt_pk_bf16_f32 v82, v82, v86
    v_cvt_f32_i32 v83, v83
    v_cvt_f32_i32 v87, v87
    v_cvt_pk_bf16_f32 v83, v83, v87
    v_and_b32 v87, 0xffff0000, v83
    v_lshlrev_b32 v83, 16, v83
    v_sub_f32 v87, v87, v151
    v_sub_f32 v83, v83, v151
    v_cvt_pk_bf16_f32 v83, v83, v87
    v_and_b32 v87, 0xffff0000, v83
    v_lshlrev_b32 v83, 16, v83
    v_mul_f32 v87, v87, v147
    v_mul_f32 v83, v83, v147
    v_cvt_pk_bf16_f32 v83, v83, v87
    v_cvt_f32_i32 v88, v88
    v_cvt_f32_i32 v92, v92
    v_cvt_pk_bf16_f32 v88, v88, v92
    v_and_b32 v92, 0xffff0000, v88
    v_lshlrev_b32 v88, 16, v88
    v_sub_f32 v92, v92, v148
    v_sub_f32 v88, v88, v148
    v_cvt_pk_bf16_f32 v88, v88, v92
    v_and_b32 v92, 0xffff0000, v88
    v_lshlrev_b32 v88, 16, v88
    v_mul_f32 v92, v92, v144
    v_mul_f32 v88, v88, v144
    v_cvt_pk_bf16_f32 v88, v88, v92
    v_cvt_f32_i32 v89, v89
    v_cvt_f32_i32 v93, v93
    v_cvt_pk_bf16_f32 v89, v89, v93
    v_and_b32 v93, 0xffff0000, v89
    v_lshlrev_b32 v89, 16, v89
    v_sub_f32 v93, v93, v149
    v_sub_f32 v89, v89, v149
    v_cvt_pk_bf16_f32 v89, v89, v93
    v_and_b32 v93, 0xffff0000, v89
    v_lshlrev_b32 v89, 16, v89
    v_mul_f32 v93, v93, v145
    v_mul_f32 v89, v89, v145
    v_cvt_pk_bf16_f32 v89, v89, v93
    v_cvt_f32_i32 v90, v90
    v_cvt_f32_i32 v94, v94
    v_cvt_pk_bf16_f32 v90, v90, v94
    v_and_b32 v94, 0xffff0000, v90
    v_lshlrev_b32 v90, 16, v90
    v_sub_f32 v94, v94, v150
    v_sub_f32 v90, v90, v150
    v_cvt_pk_bf16_f32 v90, v90, v94
    v_and_b32 v94, 0xffff0000, v90
    v_lshlrev_b32 v90, 16, v90
    v_mul_f32 v94, v94, v146
    v_mul_f32 v90, v90, v146
    v_cvt_pk_bf16_f32 v90, v90, v94
    v_cvt_f32_i32 v91, v91
    v_cvt_f32_i32 v95, v95
    v_cvt_pk_bf16_f32 v91, v91, v95
    v_and_b32 v95, 0xffff0000, v91
    v_lshlrev_b32 v91, 16, v91
    v_sub_f32 v95, v95, v151
    v_sub_f32 v91, v91, v151
    v_cvt_pk_bf16_f32 v91, v91, v95
    v_and_b32 v95, 0xffff0000, v91
    v_lshlrev_b32 v91, 16, v91
    v_mul_f32 v95, v95, v147
    v_mul_f32 v91, v91, v147
    v_cvt_pk_bf16_f32 v91, v91, v95
    v_mov_b32 v144, v64
    v_mov_b32 v148, v65
    v_mov_b32 v152, v66
    v_mov_b32 v156, v67
    v_mov_b32 v145, v72
    v_mov_b32 v149, v73
    v_mov_b32 v153, v74
    v_mov_b32 v157, v75
    v_mov_b32 v146, v80
    v_mov_b32 v150, v81
    v_mov_b32 v154, v82
    v_mov_b32 v158, v83
    v_mov_b32 v147, v88
    v_mov_b32 v151, v89
    v_mov_b32 v155, v90
    v_mov_b32 v159, v91
    s_branch dqr1

dqg2:
    s_mul_i32 s82, s65, 448
    buffer_load_dwordx4 v[32:35], v12, s[32:35], s82 offen
    s_add_u32 s82, s82, 14336
    buffer_load_dwordx4 v[36:39], v12, s[32:35], s82 offen
    s_add_u32 s82, s82, 14336
    buffer_load_dwordx4 v[40:43], v12, s[32:35], s82 offen
    s_add_u32 s82, s82, 14336
    buffer_load_dwordx4 v[44:47], v12, s[32:35], s82 offen
    s_add_u32 s82, s82, 186368
    buffer_load_dwordx4 v[48:51], v12, s[32:35], s82 offen
    s_add_u32 s82, s82, 14336
    buffer_load_dwordx4 v[52:55], v12, s[32:35], s82 offen
    s_add_u32 s82, s82, 14336
    buffer_load_dwordx4 v[56:59], v12, s[32:35], s82 offen
    s_add_u32 s82, s82, 14336
    buffer_load_dwordx4 v[60:63], v12, s[32:35], s82 offen
    v_bfe_u32 v13, v0, 3, 4
    s_and_b32 s82, s68, 2
    v_xor_b32 v13, s82, v13
    v_lshlrev_b32 v13, 3, v13
    s_lshl_b32 s82, s71, 7
    buffer_load_dwordx2 v[160:161], v13, s[36:39], s82 offen
    buffer_load_dwordx2 v[164:165], v13, s[40:43], s82 offen
    s_waitcnt vmcnt(0)
    v_and_b32 v163, 0xffff0000, v161
    v_lshlrev_b32 v162, 16, v161
    v_and_b32 v161, 0xffff0000, v160
    v_lshlrev_b32 v160, 16, v160
    v_and_b32 v167, 0xffff0000, v165
    v_lshlrev_b32 v166, 16, v165
    v_and_b32 v165, 0xffff0000, v164
    v_lshlrev_b32 v164, 16, v164
    v_cvt_f32_i32 v32, v32
    v_cvt_f32_i32 v36, v36
    v_cvt_pk_bf16_f32 v32, v32, v36
    v_and_b32 v36, 0xffff0000, v32
    v_lshlrev_b32 v32, 16, v32
    v_sub_f32 v36, v36, v164
    v_sub_f32 v32, v32, v164
    v_cvt_pk_bf16_f32 v32, v32, v36
    v_and_b32 v36, 0xffff0000, v32
    v_lshlrev_b32 v32, 16, v32
    v_mul_f32 v36, v36, v160
    v_mul_f32 v32, v32, v160
    v_cvt_pk_bf16_f32 v32, v32, v36
    v_cvt_f32_i32 v33, v33
    v_cvt_f32_i32 v37, v37
    v_cvt_pk_bf16_f32 v33, v33, v37
    v_and_b32 v37, 0xffff0000, v33
    v_lshlrev_b32 v33, 16, v33
    v_sub_f32 v37, v37, v165
    v_sub_f32 v33, v33, v165
    v_cvt_pk_bf16_f32 v33, v33, v37
    v_and_b32 v37, 0xffff0000, v33
    v_lshlrev_b32 v33, 16, v33
    v_mul_f32 v37, v37, v161
    v_mul_f32 v33, v33, v161
    v_cvt_pk_bf16_f32 v33, v33, v37
    v_cvt_f32_i32 v34, v34
    v_cvt_f32_i32 v38, v38
    v_cvt_pk_bf16_f32 v34, v34, v38
    v_and_b32 v38, 0xffff0000, v34
    v_lshlrev_b32 v34, 16, v34
    v_sub_f32 v38, v38, v166
    v_sub_f32 v34, v34, v166
    v_cvt_pk_bf16_f32 v34, v34, v38
    v_and_b32 v38, 0xffff0000, v34
    v_lshlrev_b32 v34, 16, v34
    v_mul_f32 v38, v38, v162
    v_mul_f32 v34, v34, v162
    v_cvt_pk_bf16_f32 v34, v34, v38
    v_cvt_f32_i32 v35, v35
    v_cvt_f32_i32 v39, v39
    v_cvt_pk_bf16_f32 v35, v35, v39
    v_and_b32 v39, 0xffff0000, v35
    v_lshlrev_b32 v35, 16, v35
    v_sub_f32 v39, v39, v167
    v_sub_f32 v35, v35, v167
    v_cvt_pk_bf16_f32 v35, v35, v39
    v_and_b32 v39, 0xffff0000, v35
    v_lshlrev_b32 v35, 16, v35
    v_mul_f32 v39, v39, v163
    v_mul_f32 v35, v35, v163
    v_cvt_pk_bf16_f32 v35, v35, v39
    v_cvt_f32_i32 v40, v40
    v_cvt_f32_i32 v44, v44
    v_cvt_pk_bf16_f32 v40, v40, v44
    v_and_b32 v44, 0xffff0000, v40
    v_lshlrev_b32 v40, 16, v40
    v_sub_f32 v44, v44, v164
    v_sub_f32 v40, v40, v164
    v_cvt_pk_bf16_f32 v40, v40, v44
    v_and_b32 v44, 0xffff0000, v40
    v_lshlrev_b32 v40, 16, v40
    v_mul_f32 v44, v44, v160
    v_mul_f32 v40, v40, v160
    v_cvt_pk_bf16_f32 v40, v40, v44
    v_cvt_f32_i32 v41, v41
    v_cvt_f32_i32 v45, v45
    v_cvt_pk_bf16_f32 v41, v41, v45
    v_and_b32 v45, 0xffff0000, v41
    v_lshlrev_b32 v41, 16, v41
    v_sub_f32 v45, v45, v165
    v_sub_f32 v41, v41, v165
    v_cvt_pk_bf16_f32 v41, v41, v45
    v_and_b32 v45, 0xffff0000, v41
    v_lshlrev_b32 v41, 16, v41
    v_mul_f32 v45, v45, v161
    v_mul_f32 v41, v41, v161
    v_cvt_pk_bf16_f32 v41, v41, v45
    v_cvt_f32_i32 v42, v42
    v_cvt_f32_i32 v46, v46
    v_cvt_pk_bf16_f32 v42, v42, v46
    v_and_b32 v46, 0xffff0000, v42
    v_lshlrev_b32 v42, 16, v42
    v_sub_f32 v46, v46, v166
    v_sub_f32 v42, v42, v166
    v_cvt_pk_bf16_f32 v42, v42, v46
    v_and_b32 v46, 0xffff0000, v42
    v_lshlrev_b32 v42, 16, v42
    v_mul_f32 v46, v46, v162
    v_mul_f32 v42, v42, v162
    v_cvt_pk_bf16_f32 v42, v42, v46
    v_cvt_f32_i32 v43, v43
    v_cvt_f32_i32 v47, v47
    v_cvt_pk_bf16_f32 v43, v43, v47
    v_and_b32 v47, 0xffff0000, v43
    v_lshlrev_b32 v43, 16, v43
    v_sub_f32 v47, v47, v167
    v_sub_f32 v43, v43, v167
    v_cvt_pk_bf16_f32 v43, v43, v47
    v_and_b32 v47, 0xffff0000, v43
    v_lshlrev_b32 v43, 16, v43
    v_mul_f32 v47, v47, v163
    v_mul_f32 v43, v43, v163
    v_cvt_pk_bf16_f32 v43, v43, v47
    v_cvt_f32_i32 v48, v48
    v_cvt_f32_i32 v52, v52
    v_cvt_pk_bf16_f32 v48, v48, v52
    v_and_b32 v52, 0xffff0000, v48
    v_lshlrev_b32 v48, 16, v48
    v_sub_f32 v52, v52, v164
    v_sub_f32 v48, v48, v164
    v_cvt_pk_bf16_f32 v48, v48, v52
    v_and_b32 v52, 0xffff0000, v48
    v_lshlrev_b32 v48, 16, v48
    v_mul_f32 v52, v52, v160
    v_mul_f32 v48, v48, v160
    v_cvt_pk_bf16_f32 v48, v48, v52
    v_cvt_f32_i32 v49, v49
    v_cvt_f32_i32 v53, v53
    v_cvt_pk_bf16_f32 v49, v49, v53
    v_and_b32 v53, 0xffff0000, v49
    v_lshlrev_b32 v49, 16, v49
    v_sub_f32 v53, v53, v165
    v_sub_f32 v49, v49, v165
    v_cvt_pk_bf16_f32 v49, v49, v53
    v_and_b32 v53, 0xffff0000, v49
    v_lshlrev_b32 v49, 16, v49
    v_mul_f32 v53, v53, v161
    v_mul_f32 v49, v49, v161
    v_cvt_pk_bf16_f32 v49, v49, v53
    v_cvt_f32_i32 v50, v50
    v_cvt_f32_i32 v54, v54
    v_cvt_pk_bf16_f32 v50, v50, v54
    v_and_b32 v54, 0xffff0000, v50
    v_lshlrev_b32 v50, 16, v50
    v_sub_f32 v54, v54, v166
    v_sub_f32 v50, v50, v166
    v_cvt_pk_bf16_f32 v50, v50, v54
    v_and_b32 v54, 0xffff0000, v50
    v_lshlrev_b32 v50, 16, v50
    v_mul_f32 v54, v54, v162
    v_mul_f32 v50, v50, v162
    v_cvt_pk_bf16_f32 v50, v50, v54
    v_cvt_f32_i32 v51, v51
    v_cvt_f32_i32 v55, v55
    v_cvt_pk_bf16_f32 v51, v51, v55
    v_and_b32 v55, 0xffff0000, v51
    v_lshlrev_b32 v51, 16, v51
    v_sub_f32 v55, v55, v167
    v_sub_f32 v51, v51, v167
    v_cvt_pk_bf16_f32 v51, v51, v55
    v_and_b32 v55, 0xffff0000, v51
    v_lshlrev_b32 v51, 16, v51
    v_mul_f32 v55, v55, v163
    v_mul_f32 v51, v51, v163
    v_cvt_pk_bf16_f32 v51, v51, v55
    v_cvt_f32_i32 v56, v56
    v_cvt_f32_i32 v60, v60
    v_cvt_pk_bf16_f32 v56, v56, v60
    v_and_b32 v60, 0xffff0000, v56
    v_lshlrev_b32 v56, 16, v56
    v_sub_f32 v60, v60, v164
    v_sub_f32 v56, v56, v164
    v_cvt_pk_bf16_f32 v56, v56, v60
    v_and_b32 v60, 0xffff0000, v56
    v_lshlrev_b32 v56, 16, v56
    v_mul_f32 v60, v60, v160
    v_mul_f32 v56, v56, v160
    v_cvt_pk_bf16_f32 v56, v56, v60
    v_cvt_f32_i32 v57, v57
    v_cvt_f32_i32 v61, v61
    v_cvt_pk_bf16_f32 v57, v57, v61
    v_and_b32 v61, 0xffff0000, v57
    v_lshlrev_b32 v57, 16, v57
    v_sub_f32 v61, v61, v165
    v_sub_f32 v57, v57, v165
    v_cvt_pk_bf16_f32 v57, v57, v61
    v_and_b32 v61, 0xffff0000, v57
    v_lshlrev_b32 v57, 16, v57
    v_mul_f32 v61, v61, v161
    v_mul_f32 v57, v57, v161
    v_cvt_pk_bf16_f32 v57, v57, v61
    v_cvt_f32_i32 v58, v58
    v_cvt_f32_i32 v62, v62
    v_cvt_pk_bf16_f32 v58, v58, v62
    v_and_b32 v62, 0xffff0000, v58
    v_lshlrev_b32 v58, 16, v58
    v_sub_f32 v62, v62, v166
    v_sub_f32 v58, v58, v166
    v_cvt_pk_bf16_f32 v58, v58, v62
    v_and_b32 v62, 0xffff0000, v58
    v_lshlrev_b32 v58, 16, v58
    v_mul_f32 v62, v62, v162
    v_mul_f32 v58, v58, v162
    v_cvt_pk_bf16_f32 v58, v58, v62
    v_cvt_f32_i32 v59, v59
    v_cvt_f32_i32 v63, v63
    v_cvt_pk_bf16_f32 v59, v59, v63
    v_and_b32 v63, 0xffff0000, v59
    v_lshlrev_b32 v59, 16, v59
    v_sub_f32 v63, v63, v167
    v_sub_f32 v59, v59, v167
    v_cvt_pk_bf16_f32 v59, v59, v63
    v_and_b32 v63, 0xffff0000, v59
    v_lshlrev_b32 v59, 16, v59
    v_mul_f32 v63, v63, v163
    v_mul_f32 v59, v59, v163
    v_cvt_pk_bf16_f32 v59, v59, v63
    v_mov_b32 v160, v32
    v_mov_b32 v164, v33
    v_mov_b32 v168, v34
    v_mov_b32 v172, v35
    v_mov_b32 v161, v40
    v_mov_b32 v165, v41
    v_mov_b32 v169, v42
    v_mov_b32 v173, v43
    v_mov_b32 v162, v48
    v_mov_b32 v166, v49
    v_mov_b32 v170, v50
    v_mov_b32 v174, v51
    v_mov_b32 v163, v56
    v_mov_b32 v167, v57
    v_mov_b32 v171, v58
    v_mov_b32 v175, v59
    s_branch dqr2

dqg3:
    s_mul_i32 s82, s66, 448
    buffer_load_dwordx4 v[32:35], v12, s[32:35], s82 offen
    s_add_u32 s82, s82, 14336
    buffer_load_dwordx4 v[36:39], v12, s[32:35], s82 offen
    s_add_u32 s82, s82, 14336
    buffer_load_dwordx4 v[40:43], v12, s[32:35], s82 offen
    s_add_u32 s82, s82, 14336
    buffer_load_dwordx4 v[44:47], v12, s[32:35], s82 offen
    s_add_u32 s82, s82, 186368
    buffer_load_dwordx4 v[48:51], v12, s[32:35], s82 offen
    s_add_u32 s82, s82, 14336
    buffer_load_dwordx4 v[52:55], v12, s[32:35], s82 offen
    s_add_u32 s82, s82, 14336
    buffer_load_dwordx4 v[56:59], v12, s[32:35], s82 offen
    s_add_u32 s82, s82, 14336
    buffer_load_dwordx4 v[60:63], v12, s[32:35], s82 offen
    v_bfe_u32 v13, v0, 3, 4
    s_and_b32 s82, s68, 2
    v_xor_b32 v13, s82, v13
    v_lshlrev_b32 v13, 3, v13
    s_lshl_b32 s82, s71, 7
    buffer_load_dwordx2 v[176:177], v13, s[36:39], s82 offen
    buffer_load_dwordx2 v[180:181], v13, s[40:43], s82 offen
    s_waitcnt vmcnt(0)
    v_and_b32 v179, 0xffff0000, v177
    v_lshlrev_b32 v178, 16, v177
    v_and_b32 v177, 0xffff0000, v176
    v_lshlrev_b32 v176, 16, v176
    v_and_b32 v183, 0xffff0000, v181
    v_lshlrev_b32 v182, 16, v181
    v_and_b32 v181, 0xffff0000, v180
    v_lshlrev_b32 v180, 16, v180
    v_cvt_f32_i32 v32, v32
    v_cvt_f32_i32 v36, v36
    v_cvt_pk_bf16_f32 v32, v32, v36
    v_and_b32 v36, 0xffff0000, v32
    v_lshlrev_b32 v32, 16, v32
    v_sub_f32 v36, v36, v180
    v_sub_f32 v32, v32, v180
    v_cvt_pk_bf16_f32 v32, v32, v36
    v_and_b32 v36, 0xffff0000, v32
    v_lshlrev_b32 v32, 16, v32
    v_mul_f32 v36, v36, v176
    v_mul_f32 v32, v32, v176
    v_cvt_pk_bf16_f32 v32, v32, v36
    v_cvt_f32_i32 v33, v33
    v_cvt_f32_i32 v37, v37
    v_cvt_pk_bf16_f32 v33, v33, v37
    v_and_b32 v37, 0xffff0000, v33
    v_lshlrev_b32 v33, 16, v33
    v_sub_f32 v37, v37, v181
    v_sub_f32 v33, v33, v181
    v_cvt_pk_bf16_f32 v33, v33, v37
    v_and_b32 v37, 0xffff0000, v33
    v_lshlrev_b32 v33, 16, v33
    v_mul_f32 v37, v37, v177
    v_mul_f32 v33, v33, v177
    v_cvt_pk_bf16_f32 v33, v33, v37
    v_cvt_f32_i32 v34, v34
    v_cvt_f32_i32 v38, v38
    v_cvt_pk_bf16_f32 v34, v34, v38
    v_and_b32 v38, 0xffff0000, v34
    v_lshlrev_b32 v34, 16, v34
    v_sub_f32 v38, v38, v182
    v_sub_f32 v34, v34, v182
    v_cvt_pk_bf16_f32 v34, v34, v38
    v_and_b32 v38, 0xffff0000, v34
    v_lshlrev_b32 v34, 16, v34
    v_mul_f32 v38, v38, v178
    v_mul_f32 v34, v34, v178
    v_cvt_pk_bf16_f32 v34, v34, v38
    v_cvt_f32_i32 v35, v35
    v_cvt_f32_i32 v39, v39
    v_cvt_pk_bf16_f32 v35, v35, v39
    v_and_b32 v39, 0xffff0000, v35
    v_lshlrev_b32 v35, 16, v35
    v_sub_f32 v39, v39, v183
    v_sub_f32 v35, v35, v183
    v_cvt_pk_bf16_f32 v35, v35, v39
    v_and_b32 v39, 0xffff0000, v35
    v_lshlrev_b32 v35, 16, v35
    v_mul_f32 v39, v39, v179
    v_mul_f32 v35, v35, v179
    v_cvt_pk_bf16_f32 v35, v35, v39
    v_cvt_f32_i32 v40, v40
    v_cvt_f32_i32 v44, v44
    v_cvt_pk_bf16_f32 v40, v40, v44
    v_and_b32 v44, 0xffff0000, v40
    v_lshlrev_b32 v40, 16, v40
    v_sub_f32 v44, v44, v180
    v_sub_f32 v40, v40, v180
    v_cvt_pk_bf16_f32 v40, v40, v44
    v_and_b32 v44, 0xffff0000, v40
    v_lshlrev_b32 v40, 16, v40
    v_mul_f32 v44, v44, v176
    v_mul_f32 v40, v40, v176
    v_cvt_pk_bf16_f32 v40, v40, v44
    v_cvt_f32_i32 v41, v41
    v_cvt_f32_i32 v45, v45
    v_cvt_pk_bf16_f32 v41, v41, v45
    v_and_b32 v45, 0xffff0000, v41
    v_lshlrev_b32 v41, 16, v41
    v_sub_f32 v45, v45, v181
    v_sub_f32 v41, v41, v181
    v_cvt_pk_bf16_f32 v41, v41, v45
    v_and_b32 v45, 0xffff0000, v41
    v_lshlrev_b32 v41, 16, v41
    v_mul_f32 v45, v45, v177
    v_mul_f32 v41, v41, v177
    v_cvt_pk_bf16_f32 v41, v41, v45
    v_cvt_f32_i32 v42, v42
    v_cvt_f32_i32 v46, v46
    v_cvt_pk_bf16_f32 v42, v42, v46
    v_and_b32 v46, 0xffff0000, v42
    v_lshlrev_b32 v42, 16, v42
    v_sub_f32 v46, v46, v182
    v_sub_f32 v42, v42, v182
    v_cvt_pk_bf16_f32 v42, v42, v46
    v_and_b32 v46, 0xffff0000, v42
    v_lshlrev_b32 v42, 16, v42
    v_mul_f32 v46, v46, v178
    v_mul_f32 v42, v42, v178
    v_cvt_pk_bf16_f32 v42, v42, v46
    v_cvt_f32_i32 v43, v43
    v_cvt_f32_i32 v47, v47
    v_cvt_pk_bf16_f32 v43, v43, v47
    v_and_b32 v47, 0xffff0000, v43
    v_lshlrev_b32 v43, 16, v43
    v_sub_f32 v47, v47, v183
    v_sub_f32 v43, v43, v183
    v_cvt_pk_bf16_f32 v43, v43, v47
    v_and_b32 v47, 0xffff0000, v43
    v_lshlrev_b32 v43, 16, v43
    v_mul_f32 v47, v47, v179
    v_mul_f32 v43, v43, v179
    v_cvt_pk_bf16_f32 v43, v43, v47
    v_cvt_f32_i32 v48, v48
    v_cvt_f32_i32 v52, v52
    v_cvt_pk_bf16_f32 v48, v48, v52
    v_and_b32 v52, 0xffff0000, v48
    v_lshlrev_b32 v48, 16, v48
    v_sub_f32 v52, v52, v180
    v_sub_f32 v48, v48, v180
    v_cvt_pk_bf16_f32 v48, v48, v52
    v_and_b32 v52, 0xffff0000, v48
    v_lshlrev_b32 v48, 16, v48
    v_mul_f32 v52, v52, v176
    v_mul_f32 v48, v48, v176
    v_cvt_pk_bf16_f32 v48, v48, v52
    v_cvt_f32_i32 v49, v49
    v_cvt_f32_i32 v53, v53
    v_cvt_pk_bf16_f32 v49, v49, v53
    v_and_b32 v53, 0xffff0000, v49
    v_lshlrev_b32 v49, 16, v49
    v_sub_f32 v53, v53, v181
    v_sub_f32 v49, v49, v181
    v_cvt_pk_bf16_f32 v49, v49, v53
    v_and_b32 v53, 0xffff0000, v49
    v_lshlrev_b32 v49, 16, v49
    v_mul_f32 v53, v53, v177
    v_mul_f32 v49, v49, v177
    v_cvt_pk_bf16_f32 v49, v49, v53
    v_cvt_f32_i32 v50, v50
    v_cvt_f32_i32 v54, v54
    v_cvt_pk_bf16_f32 v50, v50, v54
    v_and_b32 v54, 0xffff0000, v50
    v_lshlrev_b32 v50, 16, v50
    v_sub_f32 v54, v54, v182
    v_sub_f32 v50, v50, v182
    v_cvt_pk_bf16_f32 v50, v50, v54
    v_and_b32 v54, 0xffff0000, v50
    v_lshlrev_b32 v50, 16, v50
    v_mul_f32 v54, v54, v178
    v_mul_f32 v50, v50, v178
    v_cvt_pk_bf16_f32 v50, v50, v54
    v_cvt_f32_i32 v51, v51
    v_cvt_f32_i32 v55, v55
    v_cvt_pk_bf16_f32 v51, v51, v55
    v_and_b32 v55, 0xffff0000, v51
    v_lshlrev_b32 v51, 16, v51
    v_sub_f32 v55, v55, v183
    v_sub_f32 v51, v51, v183
    v_cvt_pk_bf16_f32 v51, v51, v55
    v_and_b32 v55, 0xffff0000, v51
    v_lshlrev_b32 v51, 16, v51
    v_mul_f32 v55, v55, v179
    v_mul_f32 v51, v51, v179
    v_cvt_pk_bf16_f32 v51, v51, v55
    v_cvt_f32_i32 v56, v56
    v_cvt_f32_i32 v60, v60
    v_cvt_pk_bf16_f32 v56, v56, v60
    v_and_b32 v60, 0xffff0000, v56
    v_lshlrev_b32 v56, 16, v56
    v_sub_f32 v60, v60, v180
    v_sub_f32 v56, v56, v180
    v_cvt_pk_bf16_f32 v56, v56, v60
    v_and_b32 v60, 0xffff0000, v56
    v_lshlrev_b32 v56, 16, v56
    v_mul_f32 v60, v60, v176
    v_mul_f32 v56, v56, v176
    v_cvt_pk_bf16_f32 v56, v56, v60
    v_cvt_f32_i32 v57, v57
    v_cvt_f32_i32 v61, v61
    v_cvt_pk_bf16_f32 v57, v57, v61
    v_and_b32 v61, 0xffff0000, v57
    v_lshlrev_b32 v57, 16, v57
    v_sub_f32 v61, v61, v181
    v_sub_f32 v57, v57, v181
    v_cvt_pk_bf16_f32 v57, v57, v61
    v_and_b32 v61, 0xffff0000, v57
    v_lshlrev_b32 v57, 16, v57
    v_mul_f32 v61, v61, v177
    v_mul_f32 v57, v57, v177
    v_cvt_pk_bf16_f32 v57, v57, v61
    v_cvt_f32_i32 v58, v58
    v_cvt_f32_i32 v62, v62
    v_cvt_pk_bf16_f32 v58, v58, v62
    v_and_b32 v62, 0xffff0000, v58
    v_lshlrev_b32 v58, 16, v58
    v_sub_f32 v62, v62, v182
    v_sub_f32 v58, v58, v182
    v_cvt_pk_bf16_f32 v58, v58, v62
    v_and_b32 v62, 0xffff0000, v58
    v_lshlrev_b32 v58, 16, v58
    v_mul_f32 v62, v62, v178
    v_mul_f32 v58, v58, v178
    v_cvt_pk_bf16_f32 v58, v58, v62
    v_cvt_f32_i32 v59, v59
    v_cvt_f32_i32 v63, v63
    v_cvt_pk_bf16_f32 v59, v59, v63
    v_and_b32 v63, 0xffff0000, v59
    v_lshlrev_b32 v59, 16, v59
    v_sub_f32 v63, v63, v183
    v_sub_f32 v59, v59, v183
    v_cvt_pk_bf16_f32 v59, v59, v63
    v_and_b32 v63, 0xffff0000, v59
    v_lshlrev_b32 v59, 16, v59
    v_mul_f32 v63, v63, v179
    v_mul_f32 v59, v59, v179
    v_cvt_pk_bf16_f32 v59, v59, v63
    v_mov_b32 v176, v32
    v_mov_b32 v180, v33
    v_mov_b32 v184, v34
    v_mov_b32 v188, v35
    v_mov_b32 v177, v40
    v_mov_b32 v181, v41
    v_mov_b32 v185, v42
    v_mov_b32 v189, v43
    v_mov_b32 v178, v48
    v_mov_b32 v182, v49
    v_mov_b32 v186, v50
    v_mov_b32 v190, v51
    v_mov_b32 v179, v56
    v_mov_b32 v183, v57
    v_mov_b32 v187, v58
    v_mov_b32 v191, v59
    s_branch dqr3

dqg4:
    s_mul_i32 s82, s67, 448
    buffer_load_dwordx4 v[32:35], v12, s[32:35], s82 offen
    s_add_u32 s82, s82, 14336
    buffer_load_dwordx4 v[36:39], v12, s[32:35], s82 offen
    s_add_u32 s82, s82, 14336
    buffer_load_dwordx4 v[40:43], v12, s[32:35], s82 offen
    s_add_u32 s82, s82, 14336
    buffer_load_dwordx4 v[44:47], v12, s[32:35], s82 offen
    s_add_u32 s82, s82, 186368
    buffer_load_dwordx4 v[48:51], v12, s[32:35], s82 offen
    s_add_u32 s82, s82, 14336
    buffer_load_dwordx4 v[52:55], v12, s[32:35], s82 offen
    s_add_u32 s82, s82, 14336
    buffer_load_dwordx4 v[56:59], v12, s[32:35], s82 offen
    s_add_u32 s82, s82, 14336
    buffer_load_dwordx4 v[60:63], v12, s[32:35], s82 offen
    v_bfe_u32 v13, v0, 3, 4
    s_and_b32 s82, s68, 2
    v_xor_b32 v13, s82, v13
    v_lshlrev_b32 v13, 3, v13
    s_lshl_b32 s82, s71, 7
    buffer_load_dwordx2 v[192:193], v13, s[36:39], s82 offen
    buffer_load_dwordx2 v[196:197], v13, s[40:43], s82 offen
    s_waitcnt vmcnt(0)
    v_and_b32 v195, 0xffff0000, v193
    v_lshlrev_b32 v194, 16, v193
    v_and_b32 v193, 0xffff0000, v192
    v_lshlrev_b32 v192, 16, v192
    v_and_b32 v199, 0xffff0000, v197
    v_lshlrev_b32 v198, 16, v197
    v_and_b32 v197, 0xffff0000, v196
    v_lshlrev_b32 v196, 16, v196
    v_cvt_f32_i32 v32, v32
    v_cvt_f32_i32 v36, v36
    v_cvt_pk_bf16_f32 v32, v32, v36
    v_and_b32 v36, 0xffff0000, v32
    v_lshlrev_b32 v32, 16, v32
    v_sub_f32 v36, v36, v196
    v_sub_f32 v32, v32, v196
    v_cvt_pk_bf16_f32 v32, v32, v36
    v_and_b32 v36, 0xffff0000, v32
    v_lshlrev_b32 v32, 16, v32
    v_mul_f32 v36, v36, v192
    v_mul_f32 v32, v32, v192
    v_cvt_pk_bf16_f32 v32, v32, v36
    v_cvt_f32_i32 v33, v33
    v_cvt_f32_i32 v37, v37
    v_cvt_pk_bf16_f32 v33, v33, v37
    v_and_b32 v37, 0xffff0000, v33
    v_lshlrev_b32 v33, 16, v33
    v_sub_f32 v37, v37, v197
    v_sub_f32 v33, v33, v197
    v_cvt_pk_bf16_f32 v33, v33, v37
    v_and_b32 v37, 0xffff0000, v33
    v_lshlrev_b32 v33, 16, v33
    v_mul_f32 v37, v37, v193
    v_mul_f32 v33, v33, v193
    v_cvt_pk_bf16_f32 v33, v33, v37
    v_cvt_f32_i32 v34, v34
    v_cvt_f32_i32 v38, v38
    v_cvt_pk_bf16_f32 v34, v34, v38
    v_and_b32 v38, 0xffff0000, v34
    v_lshlrev_b32 v34, 16, v34
    v_sub_f32 v38, v38, v198
    v_sub_f32 v34, v34, v198
    v_cvt_pk_bf16_f32 v34, v34, v38
    v_and_b32 v38, 0xffff0000, v34
    v_lshlrev_b32 v34, 16, v34
    v_mul_f32 v38, v38, v194
    v_mul_f32 v34, v34, v194
    v_cvt_pk_bf16_f32 v34, v34, v38
    v_cvt_f32_i32 v35, v35
    v_cvt_f32_i32 v39, v39
    v_cvt_pk_bf16_f32 v35, v35, v39
    v_and_b32 v39, 0xffff0000, v35
    v_lshlrev_b32 v35, 16, v35
    v_sub_f32 v39, v39, v199
    v_sub_f32 v35, v35, v199
    v_cvt_pk_bf16_f32 v35, v35, v39
    v_and_b32 v39, 0xffff0000, v35
    v_lshlrev_b32 v35, 16, v35
    v_mul_f32 v39, v39, v195
    v_mul_f32 v35, v35, v195
    v_cvt_pk_bf16_f32 v35, v35, v39
    v_cvt_f32_i32 v40, v40
    v_cvt_f32_i32 v44, v44
    v_cvt_pk_bf16_f32 v40, v40, v44
    v_and_b32 v44, 0xffff0000, v40
    v_lshlrev_b32 v40, 16, v40
    v_sub_f32 v44, v44, v196
    v_sub_f32 v40, v40, v196
    v_cvt_pk_bf16_f32 v40, v40, v44
    v_and_b32 v44, 0xffff0000, v40
    v_lshlrev_b32 v40, 16, v40
    v_mul_f32 v44, v44, v192
    v_mul_f32 v40, v40, v192
    v_cvt_pk_bf16_f32 v40, v40, v44
    v_cvt_f32_i32 v41, v41
    v_cvt_f32_i32 v45, v45
    v_cvt_pk_bf16_f32 v41, v41, v45
    v_and_b32 v45, 0xffff0000, v41
    v_lshlrev_b32 v41, 16, v41
    v_sub_f32 v45, v45, v197
    v_sub_f32 v41, v41, v197
    v_cvt_pk_bf16_f32 v41, v41, v45
    v_and_b32 v45, 0xffff0000, v41
    v_lshlrev_b32 v41, 16, v41
    v_mul_f32 v45, v45, v193
    v_mul_f32 v41, v41, v193
    v_cvt_pk_bf16_f32 v41, v41, v45
    v_cvt_f32_i32 v42, v42
    v_cvt_f32_i32 v46, v46
    v_cvt_pk_bf16_f32 v42, v42, v46
    v_and_b32 v46, 0xffff0000, v42
    v_lshlrev_b32 v42, 16, v42
    v_sub_f32 v46, v46, v198
    v_sub_f32 v42, v42, v198
    v_cvt_pk_bf16_f32 v42, v42, v46
    v_and_b32 v46, 0xffff0000, v42
    v_lshlrev_b32 v42, 16, v42
    v_mul_f32 v46, v46, v194
    v_mul_f32 v42, v42, v194
    v_cvt_pk_bf16_f32 v42, v42, v46
    v_cvt_f32_i32 v43, v43
    v_cvt_f32_i32 v47, v47
    v_cvt_pk_bf16_f32 v43, v43, v47
    v_and_b32 v47, 0xffff0000, v43
    v_lshlrev_b32 v43, 16, v43
    v_sub_f32 v47, v47, v199
    v_sub_f32 v43, v43, v199
    v_cvt_pk_bf16_f32 v43, v43, v47
    v_and_b32 v47, 0xffff0000, v43
    v_lshlrev_b32 v43, 16, v43
    v_mul_f32 v47, v47, v195
    v_mul_f32 v43, v43, v195
    v_cvt_pk_bf16_f32 v43, v43, v47
    v_cvt_f32_i32 v48, v48
    v_cvt_f32_i32 v52, v52
    v_cvt_pk_bf16_f32 v48, v48, v52
    v_and_b32 v52, 0xffff0000, v48
    v_lshlrev_b32 v48, 16, v48
    v_sub_f32 v52, v52, v196
    v_sub_f32 v48, v48, v196
    v_cvt_pk_bf16_f32 v48, v48, v52
    v_and_b32 v52, 0xffff0000, v48
    v_lshlrev_b32 v48, 16, v48
    v_mul_f32 v52, v52, v192
    v_mul_f32 v48, v48, v192
    v_cvt_pk_bf16_f32 v48, v48, v52
    v_cvt_f32_i32 v49, v49
    v_cvt_f32_i32 v53, v53
    v_cvt_pk_bf16_f32 v49, v49, v53
    v_and_b32 v53, 0xffff0000, v49
    v_lshlrev_b32 v49, 16, v49
    v_sub_f32 v53, v53, v197
    v_sub_f32 v49, v49, v197
    v_cvt_pk_bf16_f32 v49, v49, v53
    v_and_b32 v53, 0xffff0000, v49
    v_lshlrev_b32 v49, 16, v49
    v_mul_f32 v53, v53, v193
    v_mul_f32 v49, v49, v193
    v_cvt_pk_bf16_f32 v49, v49, v53
    v_cvt_f32_i32 v50, v50
    v_cvt_f32_i32 v54, v54
    v_cvt_pk_bf16_f32 v50, v50, v54
    v_and_b32 v54, 0xffff0000, v50
    v_lshlrev_b32 v50, 16, v50
    v_sub_f32 v54, v54, v198
    v_sub_f32 v50, v50, v198
    v_cvt_pk_bf16_f32 v50, v50, v54
    v_and_b32 v54, 0xffff0000, v50
    v_lshlrev_b32 v50, 16, v50
    v_mul_f32 v54, v54, v194
    v_mul_f32 v50, v50, v194
    v_cvt_pk_bf16_f32 v50, v50, v54
    v_cvt_f32_i32 v51, v51
    v_cvt_f32_i32 v55, v55
    v_cvt_pk_bf16_f32 v51, v51, v55
    v_and_b32 v55, 0xffff0000, v51
    v_lshlrev_b32 v51, 16, v51
    v_sub_f32 v55, v55, v199
    v_sub_f32 v51, v51, v199
    v_cvt_pk_bf16_f32 v51, v51, v55
    v_and_b32 v55, 0xffff0000, v51
    v_lshlrev_b32 v51, 16, v51
    v_mul_f32 v55, v55, v195
    v_mul_f32 v51, v51, v195
    v_cvt_pk_bf16_f32 v51, v51, v55
    v_cvt_f32_i32 v56, v56
    v_cvt_f32_i32 v60, v60
    v_cvt_pk_bf16_f32 v56, v56, v60
    v_and_b32 v60, 0xffff0000, v56
    v_lshlrev_b32 v56, 16, v56
    v_sub_f32 v60, v60, v196
    v_sub_f32 v56, v56, v196
    v_cvt_pk_bf16_f32 v56, v56, v60
    v_and_b32 v60, 0xffff0000, v56
    v_lshlrev_b32 v56, 16, v56
    v_mul_f32 v60, v60, v192
    v_mul_f32 v56, v56, v192
    v_cvt_pk_bf16_f32 v56, v56, v60
    v_cvt_f32_i32 v57, v57
    v_cvt_f32_i32 v61, v61
    v_cvt_pk_bf16_f32 v57, v57, v61
    v_and_b32 v61, 0xffff0000, v57
    v_lshlrev_b32 v57, 16, v57
    v_sub_f32 v61, v61, v197
    v_sub_f32 v57, v57, v197
    v_cvt_pk_bf16_f32 v57, v57, v61
    v_and_b32 v61, 0xffff0000, v57
    v_lshlrev_b32 v57, 16, v57
    v_mul_f32 v61, v61, v193
    v_mul_f32 v57, v57, v193
    v_cvt_pk_bf16_f32 v57, v57, v61
    v_cvt_f32_i32 v58, v58
    v_cvt_f32_i32 v62, v62
    v_cvt_pk_bf16_f32 v58, v58, v62
    v_and_b32 v62, 0xffff0000, v58
    v_lshlrev_b32 v58, 16, v58
    v_sub_f32 v62, v62, v198
    v_sub_f32 v58, v58, v198
    v_cvt_pk_bf16_f32 v58, v58, v62
    v_and_b32 v62, 0xffff0000, v58
    v_lshlrev_b32 v58, 16, v58
    v_mul_f32 v62, v62, v194
    v_mul_f32 v58, v58, v194
    v_cvt_pk_bf16_f32 v58, v58, v62
    v_cvt_f32_i32 v59, v59
    v_cvt_f32_i32 v63, v63
    v_cvt_pk_bf16_f32 v59, v59, v63
    v_and_b32 v63, 0xffff0000, v59
    v_lshlrev_b32 v59, 16, v59
    v_sub_f32 v63, v63, v199
    v_sub_f32 v59, v59, v199
    v_cvt_pk_bf16_f32 v59, v59, v63
    v_and_b32 v63, 0xffff0000, v59
    v_lshlrev_b32 v59, 16, v59
    v_mul_f32 v63, v63, v195
    v_mul_f32 v59, v59, v195
    v_cvt_pk_bf16_f32 v59, v59, v63
    v_mov_b32 v192, v32
    v_mov_b32 v196, v33
    v_mov_b32 v200, v34
    v_mov_b32 v204, v35
    v_mov_b32 v193, v40
    v_mov_b32 v197, v41
    v_mov_b32 v201, v42
    v_mov_b32 v205, v43
    v_mov_b32 v194, v48
    v_mov_b32 v198, v49
    v_mov_b32 v202, v50
    v_mov_b32 v206, v51
    v_mov_b32 v195, v56
    v_mov_b32 v199, v57
    v_mov_b32 v203, v58
    v_mov_b32 v207, v59
    s_branch dqr4

dqg5:
    s_mul_i32 s82, s65, 448
    s_add_u32 s82, s82, 917504
    buffer_load_dwordx4 v[32:35], v12, s[32:35], s82 offen
    s_add_u32 s82, s82, 14336
    buffer_load_dwordx4 v[36:39], v12, s[32:35], s82 offen
    s_add_u32 s82, s82, 14336
    buffer_load_dwordx4 v[40:43], v12, s[32:35], s82 offen
    s_add_u32 s82, s82, 14336
    buffer_load_dwordx4 v[44:47], v12, s[32:35], s82 offen
    s_add_u32 s82, s82, 186368
    buffer_load_dwordx4 v[48:51], v12, s[32:35], s82 offen
    s_add_u32 s82, s82, 14336
    buffer_load_dwordx4 v[52:55], v12, s[32:35], s82 offen
    s_add_u32 s82, s82, 14336
    buffer_load_dwordx4 v[56:59], v12, s[32:35], s82 offen
    s_add_u32 s82, s82, 14336
    buffer_load_dwordx4 v[60:63], v12, s[32:35], s82 offen
    v_bfe_u32 v13, v0, 3, 4
    s_and_b32 s82, s68, 2
    v_xor_b32 v13, s82, v13
    v_lshlrev_b32 v13, 3, v13
    s_lshl_b32 s82, s71, 7
    buffer_load_dwordx2 v[208:209], v13, s[36:39], s82 offen
    buffer_load_dwordx2 v[212:213], v13, s[40:43], s82 offen
    s_waitcnt vmcnt(0)
    v_and_b32 v211, 0xffff0000, v209
    v_lshlrev_b32 v210, 16, v209
    v_and_b32 v209, 0xffff0000, v208
    v_lshlrev_b32 v208, 16, v208
    v_and_b32 v215, 0xffff0000, v213
    v_lshlrev_b32 v214, 16, v213
    v_and_b32 v213, 0xffff0000, v212
    v_lshlrev_b32 v212, 16, v212
    v_cvt_f32_i32 v32, v32
    v_cvt_f32_i32 v36, v36
    v_cvt_pk_bf16_f32 v32, v32, v36
    v_and_b32 v36, 0xffff0000, v32
    v_lshlrev_b32 v32, 16, v32
    v_sub_f32 v36, v36, v212
    v_sub_f32 v32, v32, v212
    v_cvt_pk_bf16_f32 v32, v32, v36
    v_and_b32 v36, 0xffff0000, v32
    v_lshlrev_b32 v32, 16, v32
    v_mul_f32 v36, v36, v208
    v_mul_f32 v32, v32, v208
    v_cvt_pk_bf16_f32 v32, v32, v36
    v_cvt_f32_i32 v33, v33
    v_cvt_f32_i32 v37, v37
    v_cvt_pk_bf16_f32 v33, v33, v37
    v_and_b32 v37, 0xffff0000, v33
    v_lshlrev_b32 v33, 16, v33
    v_sub_f32 v37, v37, v213
    v_sub_f32 v33, v33, v213
    v_cvt_pk_bf16_f32 v33, v33, v37
    v_and_b32 v37, 0xffff0000, v33
    v_lshlrev_b32 v33, 16, v33
    v_mul_f32 v37, v37, v209
    v_mul_f32 v33, v33, v209
    v_cvt_pk_bf16_f32 v33, v33, v37
    v_cvt_f32_i32 v34, v34
    v_cvt_f32_i32 v38, v38
    v_cvt_pk_bf16_f32 v34, v34, v38
    v_and_b32 v38, 0xffff0000, v34
    v_lshlrev_b32 v34, 16, v34
    v_sub_f32 v38, v38, v214
    v_sub_f32 v34, v34, v214
    v_cvt_pk_bf16_f32 v34, v34, v38
    v_and_b32 v38, 0xffff0000, v34
    v_lshlrev_b32 v34, 16, v34
    v_mul_f32 v38, v38, v210
    v_mul_f32 v34, v34, v210
    v_cvt_pk_bf16_f32 v34, v34, v38
    v_cvt_f32_i32 v35, v35
    v_cvt_f32_i32 v39, v39
    v_cvt_pk_bf16_f32 v35, v35, v39
    v_and_b32 v39, 0xffff0000, v35
    v_lshlrev_b32 v35, 16, v35
    v_sub_f32 v39, v39, v215
    v_sub_f32 v35, v35, v215
    v_cvt_pk_bf16_f32 v35, v35, v39
    v_and_b32 v39, 0xffff0000, v35
    v_lshlrev_b32 v35, 16, v35
    v_mul_f32 v39, v39, v211
    v_mul_f32 v35, v35, v211
    v_cvt_pk_bf16_f32 v35, v35, v39
    v_cvt_f32_i32 v40, v40
    v_cvt_f32_i32 v44, v44
    v_cvt_pk_bf16_f32 v40, v40, v44
    v_and_b32 v44, 0xffff0000, v40
    v_lshlrev_b32 v40, 16, v40
    v_sub_f32 v44, v44, v212
    v_sub_f32 v40, v40, v212
    v_cvt_pk_bf16_f32 v40, v40, v44
    v_and_b32 v44, 0xffff0000, v40
    v_lshlrev_b32 v40, 16, v40
    v_mul_f32 v44, v44, v208
    v_mul_f32 v40, v40, v208
    v_cvt_pk_bf16_f32 v40, v40, v44
    v_cvt_f32_i32 v41, v41
    v_cvt_f32_i32 v45, v45
    v_cvt_pk_bf16_f32 v41, v41, v45
    v_and_b32 v45, 0xffff0000, v41
    v_lshlrev_b32 v41, 16, v41
    v_sub_f32 v45, v45, v213
    v_sub_f32 v41, v41, v213
    v_cvt_pk_bf16_f32 v41, v41, v45
    v_and_b32 v45, 0xffff0000, v41
    v_lshlrev_b32 v41, 16, v41
    v_mul_f32 v45, v45, v209
    v_mul_f32 v41, v41, v209
    v_cvt_pk_bf16_f32 v41, v41, v45
    v_cvt_f32_i32 v42, v42
    v_cvt_f32_i32 v46, v46
    v_cvt_pk_bf16_f32 v42, v42, v46
    v_and_b32 v46, 0xffff0000, v42
    v_lshlrev_b32 v42, 16, v42
    v_sub_f32 v46, v46, v214
    v_sub_f32 v42, v42, v214
    v_cvt_pk_bf16_f32 v42, v42, v46
    v_and_b32 v46, 0xffff0000, v42
    v_lshlrev_b32 v42, 16, v42
    v_mul_f32 v46, v46, v210
    v_mul_f32 v42, v42, v210
    v_cvt_pk_bf16_f32 v42, v42, v46
    v_cvt_f32_i32 v43, v43
    v_cvt_f32_i32 v47, v47
    v_cvt_pk_bf16_f32 v43, v43, v47
    v_and_b32 v47, 0xffff0000, v43
    v_lshlrev_b32 v43, 16, v43
    v_sub_f32 v47, v47, v215
    v_sub_f32 v43, v43, v215
    v_cvt_pk_bf16_f32 v43, v43, v47
    v_and_b32 v47, 0xffff0000, v43
    v_lshlrev_b32 v43, 16, v43
    v_mul_f32 v47, v47, v211
    v_mul_f32 v43, v43, v211
    v_cvt_pk_bf16_f32 v43, v43, v47
    v_cvt_f32_i32 v48, v48
    v_cvt_f32_i32 v52, v52
    v_cvt_pk_bf16_f32 v48, v48, v52
    v_and_b32 v52, 0xffff0000, v48
    v_lshlrev_b32 v48, 16, v48
    v_sub_f32 v52, v52, v212
    v_sub_f32 v48, v48, v212
    v_cvt_pk_bf16_f32 v48, v48, v52
    v_and_b32 v52, 0xffff0000, v48
    v_lshlrev_b32 v48, 16, v48
    v_mul_f32 v52, v52, v208
    v_mul_f32 v48, v48, v208
    v_cvt_pk_bf16_f32 v48, v48, v52
    v_cvt_f32_i32 v49, v49
    v_cvt_f32_i32 v53, v53
    v_cvt_pk_bf16_f32 v49, v49, v53
    v_and_b32 v53, 0xffff0000, v49
    v_lshlrev_b32 v49, 16, v49
    v_sub_f32 v53, v53, v213
    v_sub_f32 v49, v49, v213
    v_cvt_pk_bf16_f32 v49, v49, v53
    v_and_b32 v53, 0xffff0000, v49
    v_lshlrev_b32 v49, 16, v49
    v_mul_f32 v53, v53, v209
    v_mul_f32 v49, v49, v209
    v_cvt_pk_bf16_f32 v49, v49, v53
    v_cvt_f32_i32 v50, v50
    v_cvt_f32_i32 v54, v54
    v_cvt_pk_bf16_f32 v50, v50, v54
    v_and_b32 v54, 0xffff0000, v50
    v_lshlrev_b32 v50, 16, v50
    v_sub_f32 v54, v54, v214
    v_sub_f32 v50, v50, v214
    v_cvt_pk_bf16_f32 v50, v50, v54
    v_and_b32 v54, 0xffff0000, v50
    v_lshlrev_b32 v50, 16, v50
    v_mul_f32 v54, v54, v210
    v_mul_f32 v50, v50, v210
    v_cvt_pk_bf16_f32 v50, v50, v54
    v_cvt_f32_i32 v51, v51
    v_cvt_f32_i32 v55, v55
    v_cvt_pk_bf16_f32 v51, v51, v55
    v_and_b32 v55, 0xffff0000, v51
    v_lshlrev_b32 v51, 16, v51
    v_sub_f32 v55, v55, v215
    v_sub_f32 v51, v51, v215
    v_cvt_pk_bf16_f32 v51, v51, v55
    v_and_b32 v55, 0xffff0000, v51
    v_lshlrev_b32 v51, 16, v51
    v_mul_f32 v55, v55, v211
    v_mul_f32 v51, v51, v211
    v_cvt_pk_bf16_f32 v51, v51, v55
    v_cvt_f32_i32 v56, v56
    v_cvt_f32_i32 v60, v60
    v_cvt_pk_bf16_f32 v56, v56, v60
    v_and_b32 v60, 0xffff0000, v56
    v_lshlrev_b32 v56, 16, v56
    v_sub_f32 v60, v60, v212
    v_sub_f32 v56, v56, v212
    v_cvt_pk_bf16_f32 v56, v56, v60
    v_and_b32 v60, 0xffff0000, v56
    v_lshlrev_b32 v56, 16, v56
    v_mul_f32 v60, v60, v208
    v_mul_f32 v56, v56, v208
    v_cvt_pk_bf16_f32 v56, v56, v60
    v_cvt_f32_i32 v57, v57
    v_cvt_f32_i32 v61, v61
    v_cvt_pk_bf16_f32 v57, v57, v61
    v_and_b32 v61, 0xffff0000, v57
    v_lshlrev_b32 v57, 16, v57
    v_sub_f32 v61, v61, v213
    v_sub_f32 v57, v57, v213
    v_cvt_pk_bf16_f32 v57, v57, v61
    v_and_b32 v61, 0xffff0000, v57
    v_lshlrev_b32 v57, 16, v57
    v_mul_f32 v61, v61, v209
    v_mul_f32 v57, v57, v209
    v_cvt_pk_bf16_f32 v57, v57, v61
    v_cvt_f32_i32 v58, v58
    v_cvt_f32_i32 v62, v62
    v_cvt_pk_bf16_f32 v58, v58, v62
    v_and_b32 v62, 0xffff0000, v58
    v_lshlrev_b32 v58, 16, v58
    v_sub_f32 v62, v62, v214
    v_sub_f32 v58, v58, v214
    v_cvt_pk_bf16_f32 v58, v58, v62
    v_and_b32 v62, 0xffff0000, v58
    v_lshlrev_b32 v58, 16, v58
    v_mul_f32 v62, v62, v210
    v_mul_f32 v58, v58, v210
    v_cvt_pk_bf16_f32 v58, v58, v62
    v_cvt_f32_i32 v59, v59
    v_cvt_f32_i32 v63, v63
    v_cvt_pk_bf16_f32 v59, v59, v63
    v_and_b32 v63, 0xffff0000, v59
    v_lshlrev_b32 v59, 16, v59
    v_sub_f32 v63, v63, v215
    v_sub_f32 v59, v59, v215
    v_cvt_pk_bf16_f32 v59, v59, v63
    v_and_b32 v63, 0xffff0000, v59
    v_lshlrev_b32 v59, 16, v59
    v_mul_f32 v63, v63, v211
    v_mul_f32 v59, v59, v211
    v_cvt_pk_bf16_f32 v59, v59, v63
    v_mov_b32 v208, v32
    v_mov_b32 v212, v33
    v_mov_b32 v216, v34
    v_mov_b32 v220, v35
    v_mov_b32 v209, v40
    v_mov_b32 v213, v41
    v_mov_b32 v217, v42
    v_mov_b32 v221, v43
    v_mov_b32 v210, v48
    v_mov_b32 v214, v49
    v_mov_b32 v218, v50
    v_mov_b32 v222, v51
    v_mov_b32 v211, v56
    v_mov_b32 v215, v57
    v_mov_b32 v219, v58
    v_mov_b32 v223, v59
    s_branch dqr5

dqg6:
    s_mul_i32 s82, s66, 448
    s_add_u32 s82, s82, 917504
    buffer_load_dwordx4 v[32:35], v12, s[32:35], s82 offen
    s_add_u32 s82, s82, 14336
    buffer_load_dwordx4 v[36:39], v12, s[32:35], s82 offen
    s_add_u32 s82, s82, 14336
    buffer_load_dwordx4 v[40:43], v12, s[32:35], s82 offen
    s_add_u32 s82, s82, 14336
    buffer_load_dwordx4 v[44:47], v12, s[32:35], s82 offen
    s_add_u32 s82, s82, 186368
    buffer_load_dwordx4 v[48:51], v12, s[32:35], s82 offen
    s_add_u32 s82, s82, 14336
    buffer_load_dwordx4 v[52:55], v12, s[32:35], s82 offen
    s_add_u32 s82, s82, 14336
    buffer_load_dwordx4 v[56:59], v12, s[32:35], s82 offen
    s_add_u32 s82, s82, 14336
    buffer_load_dwordx4 v[60:63], v12, s[32:35], s82 offen
    v_bfe_u32 v13, v0, 3, 4
    s_and_b32 s82, s68, 2
    v_xor_b32 v13, s82, v13
    v_lshlrev_b32 v13, 3, v13
    s_lshl_b32 s82, s71, 7
    buffer_load_dwordx2 v[224:225], v13, s[36:39], s82 offen
    buffer_load_dwordx2 v[228:229], v13, s[40:43], s82 offen
    s_waitcnt vmcnt(0)
    v_and_b32 v227, 0xffff0000, v225
    v_lshlrev_b32 v226, 16, v225
    v_and_b32 v225, 0xffff0000, v224
    v_lshlrev_b32 v224, 16, v224
    v_and_b32 v231, 0xffff0000, v229
    v_lshlrev_b32 v230, 16, v229
    v_and_b32 v229, 0xffff0000, v228
    v_lshlrev_b32 v228, 16, v228
    v_cvt_f32_i32 v32, v32
    v_cvt_f32_i32 v36, v36
    v_cvt_pk_bf16_f32 v32, v32, v36
    v_and_b32 v36, 0xffff0000, v32
    v_lshlrev_b32 v32, 16, v32
    v_sub_f32 v36, v36, v228
    v_sub_f32 v32, v32, v228
    v_cvt_pk_bf16_f32 v32, v32, v36
    v_and_b32 v36, 0xffff0000, v32
    v_lshlrev_b32 v32, 16, v32
    v_mul_f32 v36, v36, v224
    v_mul_f32 v32, v32, v224
    v_cvt_pk_bf16_f32 v32, v32, v36
    v_cvt_f32_i32 v33, v33
    v_cvt_f32_i32 v37, v37
    v_cvt_pk_bf16_f32 v33, v33, v37
    v_and_b32 v37, 0xffff0000, v33
    v_lshlrev_b32 v33, 16, v33
    v_sub_f32 v37, v37, v229
    v_sub_f32 v33, v33, v229
    v_cvt_pk_bf16_f32 v33, v33, v37
    v_and_b32 v37, 0xffff0000, v33
    v_lshlrev_b32 v33, 16, v33
    v_mul_f32 v37, v37, v225
    v_mul_f32 v33, v33, v225
    v_cvt_pk_bf16_f32 v33, v33, v37
    v_cvt_f32_i32 v34, v34
    v_cvt_f32_i32 v38, v38
    v_cvt_pk_bf16_f32 v34, v34, v38
    v_and_b32 v38, 0xffff0000, v34
    v_lshlrev_b32 v34, 16, v34
    v_sub_f32 v38, v38, v230
    v_sub_f32 v34, v34, v230
    v_cvt_pk_bf16_f32 v34, v34, v38
    v_and_b32 v38, 0xffff0000, v34
    v_lshlrev_b32 v34, 16, v34
    v_mul_f32 v38, v38, v226
    v_mul_f32 v34, v34, v226
    v_cvt_pk_bf16_f32 v34, v34, v38
    v_cvt_f32_i32 v35, v35
    v_cvt_f32_i32 v39, v39
    v_cvt_pk_bf16_f32 v35, v35, v39
    v_and_b32 v39, 0xffff0000, v35
    v_lshlrev_b32 v35, 16, v35
    v_sub_f32 v39, v39, v231
    v_sub_f32 v35, v35, v231
    v_cvt_pk_bf16_f32 v35, v35, v39
    v_and_b32 v39, 0xffff0000, v35
    v_lshlrev_b32 v35, 16, v35
    v_mul_f32 v39, v39, v227
    v_mul_f32 v35, v35, v227
    v_cvt_pk_bf16_f32 v35, v35, v39
    v_cvt_f32_i32 v40, v40
    v_cvt_f32_i32 v44, v44
    v_cvt_pk_bf16_f32 v40, v40, v44
    v_and_b32 v44, 0xffff0000, v40
    v_lshlrev_b32 v40, 16, v40
    v_sub_f32 v44, v44, v228
    v_sub_f32 v40, v40, v228
    v_cvt_pk_bf16_f32 v40, v40, v44
    v_and_b32 v44, 0xffff0000, v40
    v_lshlrev_b32 v40, 16, v40
    v_mul_f32 v44, v44, v224
    v_mul_f32 v40, v40, v224
    v_cvt_pk_bf16_f32 v40, v40, v44
    v_cvt_f32_i32 v41, v41
    v_cvt_f32_i32 v45, v45
    v_cvt_pk_bf16_f32 v41, v41, v45
    v_and_b32 v45, 0xffff0000, v41
    v_lshlrev_b32 v41, 16, v41
    v_sub_f32 v45, v45, v229
    v_sub_f32 v41, v41, v229
    v_cvt_pk_bf16_f32 v41, v41, v45
    v_and_b32 v45, 0xffff0000, v41
    v_lshlrev_b32 v41, 16, v41
    v_mul_f32 v45, v45, v225
    v_mul_f32 v41, v41, v225
    v_cvt_pk_bf16_f32 v41, v41, v45
    v_cvt_f32_i32 v42, v42
    v_cvt_f32_i32 v46, v46
    v_cvt_pk_bf16_f32 v42, v42, v46
    v_and_b32 v46, 0xffff0000, v42
    v_lshlrev_b32 v42, 16, v42
    v_sub_f32 v46, v46, v230
    v_sub_f32 v42, v42, v230
    v_cvt_pk_bf16_f32 v42, v42, v46
    v_and_b32 v46, 0xffff0000, v42
    v_lshlrev_b32 v42, 16, v42
    v_mul_f32 v46, v46, v226
    v_mul_f32 v42, v42, v226
    v_cvt_pk_bf16_f32 v42, v42, v46
    v_cvt_f32_i32 v43, v43
    v_cvt_f32_i32 v47, v47
    v_cvt_pk_bf16_f32 v43, v43, v47
    v_and_b32 v47, 0xffff0000, v43
    v_lshlrev_b32 v43, 16, v43
    v_sub_f32 v47, v47, v231
    v_sub_f32 v43, v43, v231
    v_cvt_pk_bf16_f32 v43, v43, v47
    v_and_b32 v47, 0xffff0000, v43
    v_lshlrev_b32 v43, 16, v43
    v_mul_f32 v47, v47, v227
    v_mul_f32 v43, v43, v227
    v_cvt_pk_bf16_f32 v43, v43, v47
    v_cvt_f32_i32 v48, v48
    v_cvt_f32_i32 v52, v52
    v_cvt_pk_bf16_f32 v48, v48, v52
    v_and_b32 v52, 0xffff0000, v48
    v_lshlrev_b32 v48, 16, v48
    v_sub_f32 v52, v52, v228
    v_sub_f32 v48, v48, v228
    v_cvt_pk_bf16_f32 v48, v48, v52
    v_and_b32 v52, 0xffff0000, v48
    v_lshlrev_b32 v48, 16, v48
    v_mul_f32 v52, v52, v224
    v_mul_f32 v48, v48, v224
    v_cvt_pk_bf16_f32 v48, v48, v52
    v_cvt_f32_i32 v49, v49
    v_cvt_f32_i32 v53, v53
    v_cvt_pk_bf16_f32 v49, v49, v53
    v_and_b32 v53, 0xffff0000, v49
    v_lshlrev_b32 v49, 16, v49
    v_sub_f32 v53, v53, v229
    v_sub_f32 v49, v49, v229
    v_cvt_pk_bf16_f32 v49, v49, v53
    v_and_b32 v53, 0xffff0000, v49
    v_lshlrev_b32 v49, 16, v49
    v_mul_f32 v53, v53, v225
    v_mul_f32 v49, v49, v225
    v_cvt_pk_bf16_f32 v49, v49, v53
    v_cvt_f32_i32 v50, v50
    v_cvt_f32_i32 v54, v54
    v_cvt_pk_bf16_f32 v50, v50, v54
    v_and_b32 v54, 0xffff0000, v50
    v_lshlrev_b32 v50, 16, v50
    v_sub_f32 v54, v54, v230
    v_sub_f32 v50, v50, v230
    v_cvt_pk_bf16_f32 v50, v50, v54
    v_and_b32 v54, 0xffff0000, v50
    v_lshlrev_b32 v50, 16, v50
    v_mul_f32 v54, v54, v226
    v_mul_f32 v50, v50, v226
    v_cvt_pk_bf16_f32 v50, v50, v54
    v_cvt_f32_i32 v51, v51
    v_cvt_f32_i32 v55, v55
    v_cvt_pk_bf16_f32 v51, v51, v55
    v_and_b32 v55, 0xffff0000, v51
    v_lshlrev_b32 v51, 16, v51
    v_sub_f32 v55, v55, v231
    v_sub_f32 v51, v51, v231
    v_cvt_pk_bf16_f32 v51, v51, v55
    v_and_b32 v55, 0xffff0000, v51
    v_lshlrev_b32 v51, 16, v51
    v_mul_f32 v55, v55, v227
    v_mul_f32 v51, v51, v227
    v_cvt_pk_bf16_f32 v51, v51, v55
    v_cvt_f32_i32 v56, v56
    v_cvt_f32_i32 v60, v60
    v_cvt_pk_bf16_f32 v56, v56, v60
    v_and_b32 v60, 0xffff0000, v56
    v_lshlrev_b32 v56, 16, v56
    v_sub_f32 v60, v60, v228
    v_sub_f32 v56, v56, v228
    v_cvt_pk_bf16_f32 v56, v56, v60
    v_and_b32 v60, 0xffff0000, v56
    v_lshlrev_b32 v56, 16, v56
    v_mul_f32 v60, v60, v224
    v_mul_f32 v56, v56, v224
    v_cvt_pk_bf16_f32 v56, v56, v60
    v_cvt_f32_i32 v57, v57
    v_cvt_f32_i32 v61, v61
    v_cvt_pk_bf16_f32 v57, v57, v61
    v_and_b32 v61, 0xffff0000, v57
    v_lshlrev_b32 v57, 16, v57
    v_sub_f32 v61, v61, v229
    v_sub_f32 v57, v57, v229
    v_cvt_pk_bf16_f32 v57, v57, v61
    v_and_b32 v61, 0xffff0000, v57
    v_lshlrev_b32 v57, 16, v57
    v_mul_f32 v61, v61, v225
    v_mul_f32 v57, v57, v225
    v_cvt_pk_bf16_f32 v57, v57, v61
    v_cvt_f32_i32 v58, v58
    v_cvt_f32_i32 v62, v62
    v_cvt_pk_bf16_f32 v58, v58, v62
    v_and_b32 v62, 0xffff0000, v58
    v_lshlrev_b32 v58, 16, v58
    v_sub_f32 v62, v62, v230
    v_sub_f32 v58, v58, v230
    v_cvt_pk_bf16_f32 v58, v58, v62
    v_and_b32 v62, 0xffff0000, v58
    v_lshlrev_b32 v58, 16, v58
    v_mul_f32 v62, v62, v226
    v_mul_f32 v58, v58, v226
    v_cvt_pk_bf16_f32 v58, v58, v62
    v_cvt_f32_i32 v59, v59
    v_cvt_f32_i32 v63, v63
    v_cvt_pk_bf16_f32 v59, v59, v63
    v_and_b32 v63, 0xffff0000, v59
    v_lshlrev_b32 v59, 16, v59
    v_sub_f32 v63, v63, v231
    v_sub_f32 v59, v59, v231
    v_cvt_pk_bf16_f32 v59, v59, v63
    v_and_b32 v63, 0xffff0000, v59
    v_lshlrev_b32 v59, 16, v59
    v_mul_f32 v63, v63, v227
    v_mul_f32 v59, v59, v227
    v_cvt_pk_bf16_f32 v59, v59, v63
    v_mov_b32 v224, v32
    v_mov_b32 v228, v33
    v_mov_b32 v232, v34
    v_mov_b32 v236, v35
    v_mov_b32 v225, v40
    v_mov_b32 v229, v41
    v_mov_b32 v233, v42
    v_mov_b32 v237, v43
    v_mov_b32 v226, v48
    v_mov_b32 v230, v49
    v_mov_b32 v234, v50
    v_mov_b32 v238, v51
    v_mov_b32 v227, v56
    v_mov_b32 v231, v57
    v_mov_b32 v235, v58
    v_mov_b32 v239, v59
    s_branch dqr6

dqg7:
    s_mul_i32 s82, s67, 448
    s_add_u32 s82, s82, 917504
    buffer_load_dwordx4 v[32:35], v12, s[32:35], s82 offen
    s_add_u32 s82, s82, 14336
    buffer_load_dwordx4 v[36:39], v12, s[32:35], s82 offen
    s_add_u32 s82, s82, 14336
    buffer_load_dwordx4 v[40:43], v12, s[32:35], s82 offen
    s_add_u32 s82, s82, 14336
    buffer_load_dwordx4 v[44:47], v12, s[32:35], s82 offen
    s_add_u32 s82, s82, 186368
    buffer_load_dwordx4 v[48:51], v12, s[32:35], s82 offen
    s_add_u32 s82, s82, 14336
    buffer_load_dwordx4 v[52:55], v12, s[32:35], s82 offen
    s_add_u32 s82, s82, 14336
    buffer_load_dwordx4 v[56:59], v12, s[32:35], s82 offen
    s_add_u32 s82, s82, 14336
    buffer_load_dwordx4 v[60:63], v12, s[32:35], s82 offen
    v_bfe_u32 v13, v0, 3, 4
    s_and_b32 s82, s68, 2
    v_xor_b32 v13, s82, v13
    v_lshlrev_b32 v13, 3, v13
    s_lshl_b32 s82, s71, 7
    buffer_load_dwordx2 v[240:241], v13, s[36:39], s82 offen
    buffer_load_dwordx2 v[244:245], v13, s[40:43], s82 offen
    s_waitcnt vmcnt(0)
    v_and_b32 v243, 0xffff0000, v241
    v_lshlrev_b32 v242, 16, v241
    v_and_b32 v241, 0xffff0000, v240
    v_lshlrev_b32 v240, 16, v240
    v_and_b32 v247, 0xffff0000, v245
    v_lshlrev_b32 v246, 16, v245
    v_and_b32 v245, 0xffff0000, v244
    v_lshlrev_b32 v244, 16, v244
    v_cvt_f32_i32 v32, v32
    v_cvt_f32_i32 v36, v36
    v_cvt_pk_bf16_f32 v32, v32, v36
    v_and_b32 v36, 0xffff0000, v32
    v_lshlrev_b32 v32, 16, v32
    v_sub_f32 v36, v36, v244
    v_sub_f32 v32, v32, v244
    v_cvt_pk_bf16_f32 v32, v32, v36
    v_and_b32 v36, 0xffff0000, v32
    v_lshlrev_b32 v32, 16, v32
    v_mul_f32 v36, v36, v240
    v_mul_f32 v32, v32, v240
    v_cvt_pk_bf16_f32 v32, v32, v36
    v_cvt_f32_i32 v33, v33
    v_cvt_f32_i32 v37, v37
    v_cvt_pk_bf16_f32 v33, v33, v37
    v_and_b32 v37, 0xffff0000, v33
    v_lshlrev_b32 v33, 16, v33
    v_sub_f32 v37, v37, v245
    v_sub_f32 v33, v33, v245
    v_cvt_pk_bf16_f32 v33, v33, v37
    v_and_b32 v37, 0xffff0000, v33
    v_lshlrev_b32 v33, 16, v33
    v_mul_f32 v37, v37, v241
    v_mul_f32 v33, v33, v241
    v_cvt_pk_bf16_f32 v33, v33, v37
    v_cvt_f32_i32 v34, v34
    v_cvt_f32_i32 v38, v38
    v_cvt_pk_bf16_f32 v34, v34, v38
    v_and_b32 v38, 0xffff0000, v34
    v_lshlrev_b32 v34, 16, v34
    v_sub_f32 v38, v38, v246
    v_sub_f32 v34, v34, v246
    v_cvt_pk_bf16_f32 v34, v34, v38
    v_and_b32 v38, 0xffff0000, v34
    v_lshlrev_b32 v34, 16, v34
    v_mul_f32 v38, v38, v242
    v_mul_f32 v34, v34, v242
    v_cvt_pk_bf16_f32 v34, v34, v38
    v_cvt_f32_i32 v35, v35
    v_cvt_f32_i32 v39, v39
    v_cvt_pk_bf16_f32 v35, v35, v39
    v_and_b32 v39, 0xffff0000, v35
    v_lshlrev_b32 v35, 16, v35
    v_sub_f32 v39, v39, v247
    v_sub_f32 v35, v35, v247
    v_cvt_pk_bf16_f32 v35, v35, v39
    v_and_b32 v39, 0xffff0000, v35
    v_lshlrev_b32 v35, 16, v35
    v_mul_f32 v39, v39, v243
    v_mul_f32 v35, v35, v243
    v_cvt_pk_bf16_f32 v35, v35, v39
    v_cvt_f32_i32 v40, v40
    v_cvt_f32_i32 v44, v44
    v_cvt_pk_bf16_f32 v40, v40, v44
    v_and_b32 v44, 0xffff0000, v40
    v_lshlrev_b32 v40, 16, v40
    v_sub_f32 v44, v44, v244
    v_sub_f32 v40, v40, v244
    v_cvt_pk_bf16_f32 v40, v40, v44
    v_and_b32 v44, 0xffff0000, v40
    v_lshlrev_b32 v40, 16, v40
    v_mul_f32 v44, v44, v240
    v_mul_f32 v40, v40, v240
    v_cvt_pk_bf16_f32 v40, v40, v44
    v_cvt_f32_i32 v41, v41
    v_cvt_f32_i32 v45, v45
    v_cvt_pk_bf16_f32 v41, v41, v45
    v_and_b32 v45, 0xffff0000, v41
    v_lshlrev_b32 v41, 16, v41
    v_sub_f32 v45, v45, v245
    v_sub_f32 v41, v41, v245
    v_cvt_pk_bf16_f32 v41, v41, v45
    v_and_b32 v45, 0xffff0000, v41
    v_lshlrev_b32 v41, 16, v41
    v_mul_f32 v45, v45, v241
    v_mul_f32 v41, v41, v241
    v_cvt_pk_bf16_f32 v41, v41, v45
    v_cvt_f32_i32 v42, v42
    v_cvt_f32_i32 v46, v46
    v_cvt_pk_bf16_f32 v42, v42, v46
    v_and_b32 v46, 0xffff0000, v42
    v_lshlrev_b32 v42, 16, v42
    v_sub_f32 v46, v46, v246
    v_sub_f32 v42, v42, v246
    v_cvt_pk_bf16_f32 v42, v42, v46
    v_and_b32 v46, 0xffff0000, v42
    v_lshlrev_b32 v42, 16, v42
    v_mul_f32 v46, v46, v242
    v_mul_f32 v42, v42, v242
    v_cvt_pk_bf16_f32 v42, v42, v46
    v_cvt_f32_i32 v43, v43
    v_cvt_f32_i32 v47, v47
    v_cvt_pk_bf16_f32 v43, v43, v47
    v_and_b32 v47, 0xffff0000, v43
    v_lshlrev_b32 v43, 16, v43
    v_sub_f32 v47, v47, v247
    v_sub_f32 v43, v43, v247
    v_cvt_pk_bf16_f32 v43, v43, v47
    v_and_b32 v47, 0xffff0000, v43
    v_lshlrev_b32 v43, 16, v43
    v_mul_f32 v47, v47, v243
    v_mul_f32 v43, v43, v243
    v_cvt_pk_bf16_f32 v43, v43, v47
    v_cvt_f32_i32 v48, v48
    v_cvt_f32_i32 v52, v52
    v_cvt_pk_bf16_f32 v48, v48, v52
    v_and_b32 v52, 0xffff0000, v48
    v_lshlrev_b32 v48, 16, v48
    v_sub_f32 v52, v52, v244
    v_sub_f32 v48, v48, v244
    v_cvt_pk_bf16_f32 v48, v48, v52
    v_and_b32 v52, 0xffff0000, v48
    v_lshlrev_b32 v48, 16, v48
    v_mul_f32 v52, v52, v240
    v_mul_f32 v48, v48, v240
    v_cvt_pk_bf16_f32 v48, v48, v52
    v_cvt_f32_i32 v49, v49
    v_cvt_f32_i32 v53, v53
    v_cvt_pk_bf16_f32 v49, v49, v53
    v_and_b32 v53, 0xffff0000, v49
    v_lshlrev_b32 v49, 16, v49
    v_sub_f32 v53, v53, v245
    v_sub_f32 v49, v49, v245
    v_cvt_pk_bf16_f32 v49, v49, v53
    v_and_b32 v53, 0xffff0000, v49
    v_lshlrev_b32 v49, 16, v49
    v_mul_f32 v53, v53, v241
    v_mul_f32 v49, v49, v241
    v_cvt_pk_bf16_f32 v49, v49, v53
    v_cvt_f32_i32 v50, v50
    v_cvt_f32_i32 v54, v54
    v_cvt_pk_bf16_f32 v50, v50, v54
    v_and_b32 v54, 0xffff0000, v50
    v_lshlrev_b32 v50, 16, v50
    v_sub_f32 v54, v54, v246
    v_sub_f32 v50, v50, v246
    v_cvt_pk_bf16_f32 v50, v50, v54
    v_and_b32 v54, 0xffff0000, v50
    v_lshlrev_b32 v50, 16, v50
    v_mul_f32 v54, v54, v242
    v_mul_f32 v50, v50, v242
    v_cvt_pk_bf16_f32 v50, v50, v54
    v_cvt_f32_i32 v51, v51
    v_cvt_f32_i32 v55, v55
    v_cvt_pk_bf16_f32 v51, v51, v55
    v_and_b32 v55, 0xffff0000, v51
    v_lshlrev_b32 v51, 16, v51
    v_sub_f32 v55, v55, v247
    v_sub_f32 v51, v51, v247
    v_cvt_pk_bf16_f32 v51, v51, v55
    v_and_b32 v55, 0xffff0000, v51
    v_lshlrev_b32 v51, 16, v51
    v_mul_f32 v55, v55, v243
    v_mul_f32 v51, v51, v243
    v_cvt_pk_bf16_f32 v51, v51, v55
    v_cvt_f32_i32 v56, v56
    v_cvt_f32_i32 v60, v60
    v_cvt_pk_bf16_f32 v56, v56, v60
    v_and_b32 v60, 0xffff0000, v56
    v_lshlrev_b32 v56, 16, v56
    v_sub_f32 v60, v60, v244
    v_sub_f32 v56, v56, v244
    v_cvt_pk_bf16_f32 v56, v56, v60
    v_and_b32 v60, 0xffff0000, v56
    v_lshlrev_b32 v56, 16, v56
    v_mul_f32 v60, v60, v240
    v_mul_f32 v56, v56, v240
    v_cvt_pk_bf16_f32 v56, v56, v60
    v_cvt_f32_i32 v57, v57
    v_cvt_f32_i32 v61, v61
    v_cvt_pk_bf16_f32 v57, v57, v61
    v_and_b32 v61, 0xffff0000, v57
    v_lshlrev_b32 v57, 16, v57
    v_sub_f32 v61, v61, v245
    v_sub_f32 v57, v57, v245
    v_cvt_pk_bf16_f32 v57, v57, v61
    v_and_b32 v61, 0xffff0000, v57
    v_lshlrev_b32 v57, 16, v57
    v_mul_f32 v61, v61, v241
    v_mul_f32 v57, v57, v241
    v_cvt_pk_bf16_f32 v57, v57, v61
    v_cvt_f32_i32 v58, v58
    v_cvt_f32_i32 v62, v62
    v_cvt_pk_bf16_f32 v58, v58, v62
    v_and_b32 v62, 0xffff0000, v58
    v_lshlrev_b32 v58, 16, v58
    v_sub_f32 v62, v62, v246
    v_sub_f32 v58, v58, v246
    v_cvt_pk_bf16_f32 v58, v58, v62
    v_and_b32 v62, 0xffff0000, v58
    v_lshlrev_b32 v58, 16, v58
    v_mul_f32 v62, v62, v242
    v_mul_f32 v58, v58, v242
    v_cvt_pk_bf16_f32 v58, v58, v62
    v_cvt_f32_i32 v59, v59
    v_cvt_f32_i32 v63, v63
    v_cvt_pk_bf16_f32 v59, v59, v63
    v_and_b32 v63, 0xffff0000, v59
    v_lshlrev_b32 v59, 16, v59
    v_sub_f32 v63, v63, v247
    v_sub_f32 v59, v59, v247
    v_cvt_pk_bf16_f32 v59, v59, v63
    v_and_b32 v63, 0xffff0000, v59
    v_lshlrev_b32 v59, 16, v59
    v_mul_f32 v63, v63, v243
    v_mul_f32 v59, v59, v243
    v_cvt_pk_bf16_f32 v59, v59, v63
    v_mov_b32 v240, v32
    v_mov_b32 v244, v33
    v_mov_b32 v248, v34
    v_mov_b32 v252, v35
    v_mov_b32 v241, v40
    v_mov_b32 v245, v41
    v_mov_b32 v249, v42
    v_mov_b32 v253, v43
    v_mov_b32 v242, v48
    v_mov_b32 v246, v49
    v_mov_b32 v250, v50
    v_mov_b32 v254, v51
    v_mov_b32 v243, v56
    v_mov_b32 v247, v57
    v_mov_b32 v251, v58
    v_mov_b32 v255, v59
    s_branch dqr7

.section .rodata,"a"
.p2align 6
.amdhsa_kernel standalone__weight_only_int_quip__sampling_kernel
  .amdhsa_next_free_vgpr 512
  .amdhsa_next_free_sgpr 102
  .amdhsa_accum_offset 256
  .amdhsa_group_segment_fixed_size 0
  .amdhsa_kernarg_size 72
  .amdhsa_user_sgpr_count 2
  .amdhsa_user_sgpr_kernarg_segment_ptr 1
  .amdhsa_system_sgpr_workgroup_id_x 1
.end_amdhsa_kernel
```
